```python
import torch

def _softmax(x, axis=-1):
    return torch.softmax(x, dim=axis)
def _gelu(x):
    return torch.nn.functional.gelu(x, approximate="tanh")
def _silu(x):
    return torch.nn.functional.silu(x)
def _sigmoid(x):
    return torch.sigmoid(x)
def _layernorm(x, axis=-1, eps=1e-5):
    m = x.mean(dim=axis, keepdim=True)
    v = x.var(dim=axis, keepdim=True, unbiased=False)
    return (x - m) / torch.sqrt(v + eps)
def _scatter_add(tgt, idx, src, axis=0):
    return tgt.clone().index_add_(axis, idx, src)
def _segment_sum(src, seg, n):
    out = torch.zeros((n,) + src.shape[1:], dtype=src.dtype)
    return out.index_add_(0, seg, src)
def _pad(x, pw):
    flat = tuple(v for pair in reversed(pw) for v in pair)
    return torch.nn.functional.pad(x, flat)

kernel_name = 'gated_mix__linear_attn_block__spectral_gfnet__prompt'

def setup_inputs():

    _w = (lambda a: (lambda t: t.to(torch.bfloat16) if t.is_floating_point() else t)(torch.as_tensor(a)))
    def _A_setup():
        B, S, D = 1, 2048, 640
        return {
            "x": _w((lambda *s: torch.randn(*s, dtype=torch.bfloat16) * 0.05)(B, S, D)),
            "wqkv": _w((lambda *s: torch.randn(*s, dtype=torch.bfloat16) * 0.4)(D, 3 * D)),
            "wo": _w((lambda *s: torch.randn(*s, dtype=torch.bfloat16) * 0.05)(D, D)),
        }
    _A_in = _A_setup()

    def _B_setup():
        B, S, D = 1, 2048, 640
        Df = D // 2 + 1
        return {
            "x": _w((lambda *s: torch.randn(*s, dtype=torch.bfloat16) * 0.05)(B, S, D)),
            "w_r": _w((lambda *s: torch.randn(*s, dtype=torch.bfloat16) * 1.6)(S, Df) * 0.02),
            "w_i": _w((lambda *s: torch.randn(*s, dtype=torch.bfloat16) * 1.6)(S, Df) * 0.02),
        }
    _B_in = _B_setup()

    return {
        "A_x": _A_in["x"],
        "A_wqkv": _A_in["wqkv"],
        "A_wo": _A_in["wo"],
        "B_x": _B_in["x"],
        "B_w_r": _B_in["w_r"],
        "B_w_i": _B_in["w_i"],
        "gate_w": _w((lambda *s: torch.randn(*s, dtype=torch.bfloat16) * 0.05)(640) * 16.0),
    }

def reference(A_x, A_wqkv, A_wo, B_x, B_w_r, B_w_i, gate_w):
    def _A_ref(x, wqkv, wo):
        B, S, D = x.shape
        H = 32; Dh = D // H
        qkv = (lambda x, *d: x.permute(*d))((x @ wqkv).reshape(B, S, 3, H, Dh), 2, 0, 3, 1, 4)
        q, k, v = qkv[0], qkv[1], qkv[2]
        phi = lambda t: torch.where(t > 0, t + 1, torch.exp(t)) + 1e-6
        pq, pk = phi(q), phi(k)
        kv = torch.einsum("bhsd,bhse->bhde", pk, v)
        z = torch.einsum("bhsd->bhd", pk)
        num = torch.einsum("bhqd,bhde->bhqe", pq, kv)
        den = torch.einsum("bhqd,bhd->bhq", pq, z)[..., None] + 1e-6
        o = num / den
        return (lambda x, *d: x.permute(*d))(o, 0, 2, 1, 3).reshape(B, S, D) @ wo

    def _B_ref(x, w_r, w_i):
        B, S, D = x.shape
        X = (lambda x, axes=(-2,-1): torch.fft.rfft2(x.float(), dim=axes))(x, axes=(-2, -1))
        W = w_r + 1j * w_i
        X = X * W
        y = (lambda x, s, axes=(-2,-1): torch.fft.irfft2(x, s=s, dim=axes).to(torch.bfloat16))(X, (S, D), axes=(-2, -1))
        return y

    x = A_x
    g = _sigmoid((x * gate_w).sum(-1, keepdims=True))
    a = _A_ref(x, A_wqkv, A_wo)
    b = _B_ref(x, B_w_r, B_w_i)
    return g * a + (1 - g) * b
```

```asm
; @launch kernel=k1_kernel grid=(256,1,1) block=(512,1,1) lds=151808
; @launch kernel=k3_kernel grid=(256,1,1) block=(256,1,1) lds=147456
.amdgcn_target "amdgcn-amd-amdhsa--gfx950"
.text
.globl k1_kernel
.p2align 8
.type k1_kernel,@function
k1_kernel:
s_cmp_ge_u32 s2, 256
s_cbranch_scc1 k1_end
s_load_dwordx4 s[4:7], s[0:1], 0
s_load_dwordx2 s[16:17], s[0:1], 72
s_load_dwordx2 s[56:57], s[0:1], 48
s_load_dwordx2 s[64:65], s[0:1], 64
v_and_b32 v1, 63, v0
v_lshrrev_b32 v12, 6, v0
v_lshrrev_b32 v2, 4, v1
v_readfirstlane_b32 s63, v12
v_and_b32 v3, 15, v1
s_and_b32 s32, s2, 7
s_lshr_b32 s33, s2, 3
s_add_u32 s33, s33, 8
s_and_b32 s33, s33, 31
s_and_b32 s20, s32, 1
s_lshl_b32 s20, s20, 3
s_and_b32 s34, s33, 7
s_add_u32 s20, s20, s34
s_lshr_b32 s21, s32, 1
s_lshr_b32 s35, s33, 3
s_and_b32 s22, s63, 3
s_lshl_b32 s29, s20, 2
s_add_u32 s29, s29, s22
s_lshl_b32 s48, s22, 12
s_add_u32 s48, s48, 20480
s_lshl_b32 s36, s35, 2
s_add_u32 s36, s36, s21
s_sub_u32 s36, s36, 4
s_add_u32 s46, s34, s35
s_and_b32 s46, s46, 3
s_mul_i32 s46, s46, 5
s_lshr_b32 s46, s46, 1
s_cmp_eq_u32 s35, 3
s_cselect_b32 s47, 81920, 0
s_add_u32 s48, s48, s47
v_lshlrev_b32 v11, 4, v1
s_mov_b32 s18, 12468224
s_mov_b32 s19, 0x00020000
s_movk_i32 s66, 256
s_mov_b32 s67, 0x00020000
s_and_b32 s8, s34, 7
s_lshl_b32 s8, s8, 3
s_add_u32 s8, s8, s63
s_cmp_ge_u32 s8, 4
s_cbranch_scc1 k1_ncpf
s_getpc_b64 s[12:13]
s_add_u32 s12, s12, k1_kernel@rel32@lo+4
s_addc_u32 s13, s13, k1_kernel@rel32@hi+12
s_mov_b32 s14, k3_kernel-k1_kernel
s_mov_b32 s15, 0x00020000
s_lshl_b32 s8, s8, 13
v_lshlrev_b32 v10, 7, v1
buffer_load_dword v0, v10, s[12:15], s8 offen
s_nop 0
k1_ncpf:
s_cmp_lt_u32 s63, 4
s_cbranch_scc1 k1_cons
v_lshrrev_b32 v12, 3, v1
v_lshlrev_b32 v12, 6, v12
v_add_u32 v12, s29, v12
v_mul_u32_u24 v12, 1280, v12
v_and_b32 v13, 7, v1
v_xor_b32 v13, v13, v2
v_lshl_add_u32 v4, v13, 4, v12
v_xor_b32 v13, 4, v13
v_lshl_add_u32 v5, v13, 4, v12
v_add_u32 v5, 655360, v5
v_add_u32 v6, 1310720, v4
v_add_u32 v7, 1310720, v5
s_mov_b32 s10, 2621440
s_mov_b32 s11, 0x00020000
s_mov_b32 s61, s48
s_add_u32 s62, s48, 147456
s_mul_i32 s26, s46, 245760
s_mov_b32 s45, s46
s_lshl_b32 s46, s46, 7
s_cmp_eq_u32 s35, 3
s_cbranch_scc1 k1_pf
s_mul_i32 s37, s36, 160
s_add_u32 s37, s37, 1280
s_mul_i32 s24, s21, 320
s_cmp_lg_u32 s35, 0
s_cselect_b32 s24, s37, s24
s_cselect_b32 s25, 1120, 0
s_lshl_b32 s60, s22, 10
v_lshrrev_b32 v12, 2, v1
v_lshrrev_b32 v13, 4, v1
v_and_b32 v13, 2, v13
v_and_b32 v14, 3, v1
v_xor_b32 v14, v13, v14
s_lshl_b32 s38, s22, 4
v_add_u32 v12, s38, v12
v_mul_u32_u24 v12, 3840, v12
v_lshl_add_u32 v12, v14, 4, v12
v_add_u32 v244, s24, v12
v_add_u32 v245, 64, v244
v_lshrrev_b32 v13, 1, v14
v_mul_lo_u32 v13, v13, s25
v_add3_u32 v246, v244, v13, 64
v_add_u32 v246, 64, v246
v_add_u32 v247, s25, v244
v_add_u32 v247, 192, v247
v_add_u32 v248, 64, v247
s_mov_b32 s14, 2457600
s_mov_b32 s15, 0x00020000
s_waitcnt lgkmcnt(0)
s_mov_b32 s8, s4
s_mov_b32 s9, s5
s_mov_b32 s12, s6
s_mov_b32 s13, s7
s_add_u32 m0, s60, 0
s_nop 0
buffer_load_dwordx4 v244, s[12:15], s26 offen lds
s_add_u32 m0, s61, 0
s_nop 0
buffer_load_dwordx4 v4, s[8:11], s46 offen lds
s_add_u32 m0, s60, 4096
s_nop 0
buffer_load_dwordx4 v245, s[12:15], s26 offen lds
s_add_u32 m0, s61, 1024
s_nop 0
buffer_load_dwordx4 v5, s[8:11], s46 offen lds
s_add_u32 m0, s60, 8192
s_nop 0
buffer_load_dwordx4 v246, s[12:15], s26 offen lds
s_add_u32 m0, s61, 2048
s_nop 0
buffer_load_dwordx4 v6, s[8:11], s46 offen lds
s_add_u32 m0, s60, 12288
s_nop 0
buffer_load_dwordx4 v247, s[12:15], s26 offen lds
s_add_u32 m0, s61, 3072
s_nop 0
buffer_load_dwordx4 v7, s[8:11], s46 offen lds
s_add_u32 m0, s60, 16384
s_nop 0
buffer_load_dwordx4 v248, s[12:15], s26 offen lds
s_add_u32 s46, s46, 128
s_add_u32 s26, s26, 245760
s_cmp_eq_u32 s46, 1280
s_cselect_b32 s46, 0, s46
s_cselect_b32 s26, 0, s26
s_add_u32 s61, s61, 36864
s_add_u32 s60, s60, 36864
s_cmp_eq_u32 s61, s62
s_cselect_b32 s61, s48, s61
s_cselect_b32 s47, 147456, 0
s_sub_u32 s60, s60, s47
s_add_u32 m0, s60, 0
s_nop 0
buffer_load_dwordx4 v244, s[12:15], s26 offen lds
s_add_u32 m0, s61, 0
s_nop 0
buffer_load_dwordx4 v4, s[8:11], s46 offen lds
s_add_u32 m0, s60, 4096
s_nop 0
buffer_load_dwordx4 v245, s[12:15], s26 offen lds
s_add_u32 m0, s61, 1024
s_nop 0
buffer_load_dwordx4 v5, s[8:11], s46 offen lds
s_add_u32 m0, s60, 8192
s_nop 0
buffer_load_dwordx4 v246, s[12:15], s26 offen lds
s_add_u32 m0, s61, 2048
s_nop 0
buffer_load_dwordx4 v6, s[8:11], s46 offen lds
s_add_u32 m0, s60, 12288
s_nop 0
buffer_load_dwordx4 v247, s[12:15], s26 offen lds
s_add_u32 m0, s61, 3072
s_nop 0
buffer_load_dwordx4 v7, s[8:11], s46 offen lds
s_add_u32 m0, s60, 16384
s_nop 0
buffer_load_dwordx4 v248, s[12:15], s26 offen lds
s_add_u32 s46, s46, 128
s_add_u32 s26, s26, 245760
s_cmp_eq_u32 s46, 1280
s_cselect_b32 s46, 0, s46
s_cselect_b32 s26, 0, s26
s_add_u32 s61, s61, 36864
s_add_u32 s60, s60, 36864
s_cmp_eq_u32 s61, s62
s_cselect_b32 s61, s48, s61
s_cselect_b32 s47, 147456, 0
s_sub_u32 s60, s60, s47
s_load_dwordx4 s[4:7], s[0:1], 32
s_sub_u32 s27, s33, 8
s_and_b32 s28, s27, 3
s_cmp_eq_u32 s27, 20
s_cselect_b32 s28, s22, s28
s_lshl_b32 s37, s32, 2
s_add_u32 s28, s28, s37
s_and_b32 s23, s27, 28
s_add_u32 s23, s23, s22
s_mul_i32 s37, s28, 20
s_add_u32 s37, s37, s23
s_lshl_b32 s37, s37, 12
s_add_u32 s37, s37, 2621440
s_mul_i32 s38, s22, 6144
s_add_u32 s38, s38, 73728
v_add_u32 v8, 0, v1
v_mul_u32_u24 v9, 171, v8
v_lshrrev_b32 v9, 9, v9
v_mul_u32_u24 v12, 20496, v9
v_lshl_add_u32 v12, v8, 4, v12
v_add_u32 v8, 64, v1
v_mul_u32_u24 v9, 171, v8
v_lshrrev_b32 v9, 9, v9
v_mul_u32_u24 v13, 20496, v9
v_lshl_add_u32 v13, v8, 4, v13
v_add_u32 v8, 128, v1
v_mul_u32_u24 v9, 171, v8
v_lshrrev_b32 v9, 9, v9
v_mul_u32_u24 v14, 20496, v9
v_lshl_add_u32 v14, v8, 4, v14
s_mul_i32 s39, s28, 642
s_lshl_b32 s40, s23, 5
s_add_u32 s39, s39, s40
s_and_b32 s41, s39, 15
s_sub_u32 s39, s39, s41
s_add_u32 s41, s41, s38
v_mov_b32 v112, 0
v_mov_b32 v113, 0
v_mov_b32 v114, 0
v_mov_b32 v115, 0
v_mov_b32 v116, 0
v_mov_b32 v117, 0
v_mov_b32 v118, 0
v_mov_b32 v119, 0
v_mov_b32 v120, 0
v_mov_b32 v121, 0
v_mov_b32 v122, 0
v_mov_b32 v123, 0
v_mov_b32 v124, 0
v_mov_b32 v125, 0
v_mov_b32 v126, 0
v_mov_b32 v127, 0
v_mov_b32 v128, 0
v_mov_b32 v129, 0
v_mov_b32 v130, 0
v_mov_b32 v131, 0
v_mov_b32 v132, 0
v_mov_b32 v133, 0
v_mov_b32 v134, 0
v_mov_b32 v135, 0
v_mov_b32 v136, 0
v_mov_b32 v137, 0
v_mov_b32 v138, 0
v_mov_b32 v139, 0
v_mov_b32 v140, 0
v_mov_b32 v141, 0
v_mov_b32 v142, 0
v_mov_b32 v143, 0
s_mov_b32 s44, 8
s_nop 0
k1_ploop:
s_waitcnt vmcnt(9)
s_barrier
s_add_u32 m0, s60, 0
s_nop 0
buffer_load_dwordx4 v244, s[12:15], s26 offen lds
s_add_u32 m0, s61, 0
s_nop 0
buffer_load_dwordx4 v4, s[8:11], s46 offen lds
s_add_u32 m0, s60, 4096
s_nop 0
buffer_load_dwordx4 v245, s[12:15], s26 offen lds
s_add_u32 m0, s61, 1024
s_nop 0
buffer_load_dwordx4 v5, s[8:11], s46 offen lds
s_add_u32 m0, s60, 8192
s_nop 0
buffer_load_dwordx4 v246, s[12:15], s26 offen lds
s_add_u32 m0, s61, 2048
s_nop 0
buffer_load_dwordx4 v6, s[8:11], s46 offen lds
s_add_u32 m0, s60, 12288
s_nop 0
buffer_load_dwordx4 v247, s[12:15], s26 offen lds
s_add_u32 m0, s61, 3072
s_nop 0
buffer_load_dwordx4 v7, s[8:11], s46 offen lds
s_add_u32 m0, s60, 16384
s_nop 0
buffer_load_dwordx4 v248, s[12:15], s26 offen lds
s_add_u32 s46, s46, 128
s_add_u32 s26, s26, 245760
s_cmp_eq_u32 s46, 1280
s_cselect_b32 s46, 0, s46
s_cselect_b32 s26, 0, s26
s_add_u32 s61, s61, 36864
s_add_u32 s60, s60, 36864
s_cmp_eq_u32 s61, s62
s_cselect_b32 s61, s48, s61
s_cselect_b32 s47, 147456, 0
s_sub_u32 s60, s60, s47
s_sub_u32 s44, s44, 1
s_cmp_lg_u32 s44, 0
s_cbranch_scc1 k1_ploop
s_waitcnt vmcnt(9) lgkmcnt(0)
s_barrier
s_cmp_eq_u32 s35, 0
s_cbranch_scc1 k1_pnone
s_branch k1_mid2
k1_mid:
s_and_b32 s28, s27, 3
s_cmp_eq_u32 s27, 20
s_cselect_b32 s28, s22, s28
s_lshl_b32 s37, s32, 2
s_add_u32 s28, s28, s37
s_and_b32 s23, s27, 28
s_add_u32 s23, s23, s22
s_mul_i32 s37, s28, 20
s_add_u32 s37, s37, s23
s_lshl_b32 s37, s37, 12
s_add_u32 s37, s37, 2621440
s_mul_i32 s38, s22, 6144
s_add_u32 s38, s38, 73728
v_add_u32 v8, 0, v1
v_mul_u32_u24 v9, 171, v8
v_lshrrev_b32 v9, 9, v9
v_mul_u32_u24 v12, 20496, v9
v_lshl_add_u32 v12, v8, 4, v12
v_add_u32 v8, 64, v1
v_mul_u32_u24 v9, 171, v8
v_lshrrev_b32 v9, 9, v9
v_mul_u32_u24 v13, 20496, v9
v_lshl_add_u32 v13, v8, 4, v13
v_add_u32 v8, 128, v1
v_mul_u32_u24 v9, 171, v8
v_lshrrev_b32 v9, 9, v9
v_mul_u32_u24 v14, 20496, v9
v_lshl_add_u32 v14, v8, 4, v14
s_mul_i32 s39, s28, 642
s_lshl_b32 s40, s23, 5
s_add_u32 s39, s39, s40
s_and_b32 s41, s39, 15
s_sub_u32 s39, s39, s41
s_add_u32 s41, s41, s38
v_mov_b32 v112, 0
v_mov_b32 v113, 0
v_mov_b32 v114, 0
v_mov_b32 v115, 0
v_mov_b32 v116, 0
v_mov_b32 v117, 0
v_mov_b32 v118, 0
v_mov_b32 v119, 0
v_mov_b32 v120, 0
v_mov_b32 v121, 0
v_mov_b32 v122, 0
v_mov_b32 v123, 0
v_mov_b32 v124, 0
v_mov_b32 v125, 0
v_mov_b32 v126, 0
v_mov_b32 v127, 0
v_mov_b32 v128, 0
v_mov_b32 v129, 0
v_mov_b32 v130, 0
v_mov_b32 v131, 0
v_mov_b32 v132, 0
v_mov_b32 v133, 0
v_mov_b32 v134, 0
v_mov_b32 v135, 0
v_mov_b32 v136, 0
v_mov_b32 v137, 0
v_mov_b32 v138, 0
v_mov_b32 v139, 0
v_mov_b32 v140, 0
v_mov_b32 v141, 0
v_mov_b32 v142, 0
v_mov_b32 v143, 0
s_nop 1
k1_mid2:
s_mov_b32 s8, s4
s_mov_b32 s9, s5
s_mov_b32 s10, 1314816
s_mov_b32 s11, 0x00020000
s_mov_b32 s12, s6
s_mov_b32 s13, s7
s_mov_b32 s14, 1314816
s_mov_b32 s15, 0x00020000
s_cmp_eq_u32 s27, 20
s_cbranch_scc1 k1_w2
s_add_u32 m0, s38, 0
s_nop 0
buffer_load_dwordx4 v12, s[8:11], s39 offen lds
s_add_u32 m0, s38, 3072
s_nop 0
buffer_load_dwordx4 v12, s[12:15], s39 offen lds
s_add_u32 m0, s38, 1024
s_nop 0
buffer_load_dwordx4 v13, s[8:11], s39 offen lds
s_add_u32 m0, s38, 4096
s_nop 0
buffer_load_dwordx4 v13, s[12:15], s39 offen lds
s_add_u32 m0, s38, 2048
s_nop 0
buffer_load_dwordx4 v14, s[8:11], s39 offen lds
s_add_u32 m0, s38, 5120
s_nop 0
buffer_load_dwordx4 v14, s[12:15], s39 offen lds
s_branch k1_w3
k1_w2:
v_mul_u32_u24 v8, 82176, v2
s_mul_i32 s39, s28, 642
s_add_u32 s39, s39, 640
buffer_load_short_d16_hi v112, v8, s[8:11], s39 offen
buffer_load_short_d16_hi v128, v8, s[12:15], s39 offen
s_add_u32 s39, s39, 20544
buffer_load_short_d16_hi v113, v8, s[8:11], s39 offen
buffer_load_short_d16_hi v129, v8, s[12:15], s39 offen
s_add_u32 s39, s39, 20544
buffer_load_short_d16_hi v114, v8, s[8:11], s39 offen
buffer_load_short_d16_hi v130, v8, s[12:15], s39 offen
s_add_u32 s39, s39, 20544
buffer_load_short_d16_hi v115, v8, s[8:11], s39 offen
buffer_load_short_d16_hi v131, v8, s[12:15], s39 offen
s_add_u32 s39, s39, 267072
buffer_load_short_d16_hi v116, v8, s[8:11], s39 offen
buffer_load_short_d16_hi v132, v8, s[12:15], s39 offen
s_add_u32 s39, s39, 20544
buffer_load_short_d16_hi v117, v8, s[8:11], s39 offen
buffer_load_short_d16_hi v133, v8, s[12:15], s39 offen
s_add_u32 s39, s39, 20544
buffer_load_short_d16_hi v118, v8, s[8:11], s39 offen
buffer_load_short_d16_hi v134, v8, s[12:15], s39 offen
s_add_u32 s39, s39, 20544
buffer_load_short_d16_hi v119, v8, s[8:11], s39 offen
buffer_load_short_d16_hi v135, v8, s[12:15], s39 offen
s_add_u32 s39, s39, 267072
buffer_load_short_d16_hi v120, v8, s[8:11], s39 offen
buffer_load_short_d16_hi v136, v8, s[12:15], s39 offen
s_add_u32 s39, s39, 20544
buffer_load_short_d16_hi v121, v8, s[8:11], s39 offen
buffer_load_short_d16_hi v137, v8, s[12:15], s39 offen
s_add_u32 s39, s39, 20544
buffer_load_short_d16_hi v122, v8, s[8:11], s39 offen
buffer_load_short_d16_hi v138, v8, s[12:15], s39 offen
s_add_u32 s39, s39, 20544
buffer_load_short_d16_hi v123, v8, s[8:11], s39 offen
buffer_load_short_d16_hi v139, v8, s[12:15], s39 offen
s_add_u32 s39, s39, 267072
buffer_load_short_d16_hi v124, v8, s[8:11], s39 offen
buffer_load_short_d16_hi v140, v8, s[12:15], s39 offen
s_add_u32 s39, s39, 20544
buffer_load_short_d16_hi v125, v8, s[8:11], s39 offen
buffer_load_short_d16_hi v141, v8, s[12:15], s39 offen
s_add_u32 s39, s39, 20544
buffer_load_short_d16_hi v126, v8, s[8:11], s39 offen
buffer_load_short_d16_hi v142, v8, s[12:15], s39 offen
s_add_u32 s39, s39, 20544
buffer_load_short_d16_hi v127, v8, s[8:11], s39 offen
buffer_load_short_d16_hi v143, v8, s[12:15], s39 offen
k1_w3:
s_cmp_eq_u32 s35, 3
s_cbranch_scc1 k1_w4
s_waitcnt vmcnt(6)
s_barrier
k1_w4:
s_barrier
s_barrier
s_setprio 2
buffer_load_dwordx2 v[252:253], off, s[64:67], 0 sc1
v_mul_u32_u24 v9, 192, v2
v_lshl_add_u32 v9, v3, 1, v9
v_add_u32 v9, s41, v9
s_lshl_b32 s42, s22, 12
s_add_u32 s42, s42, 98304
v_lshrrev_b32 v8, 2, v1
v_and_b32 v15, 3, v1
v_mul_u32_u24 v10, 40960, v8
v_lshl_add_u32 v10, v15, 4, v10
v_lshlrev_b32 v249, 2, v15
v_xor_b32 v249, v249, v8
v_lshl_add_u32 v249, v249, 4, s42
v_lshl_add_u32 v249, v15, 8, v249
v_lshlrev_b32 v15, 6, v2
v_xor_b32 v15, v15, v11
v_add_u32 v15, s42, v15
s_lshl_b32 s40, s23, 11
s_lshl_b32 s41, s28, 6
s_add_u32 s40, s40, s41
s_add_u32 s40, s40, 5242880
s_and_b32 s41, s27, 28
s_mul_i32 s42, s41, 52
s_lshr_b32 s42, s42, 8
s_add_u32 s41, s41, 3
s_mul_i32 s41, s41, 52
s_lshr_b32 s41, s41, 8
s_sub_u32 s41, s41, s42
s_cmp_ge_u32 s27, 20
s_cselect_b32 s41, 0, s41
s_cselect_b32 s42, 0, s42
v_and_b32 v250, s41, v2
v_lshlrev_b32 v250, 11, v250
v_lshl_add_u32 v250, v3, 7, v250
s_lshl_b32 s41, s42, 11
s_lshl_b32 s42, s32, 15
s_add_u32 s41, s41, s42
s_add_u32 s41, s41, 12197888
v_mov_b32 v251, 151552
v_mul_u32_u24 v226, v2, v3
v_cvt_f32_u32 v225, v3
v_cvt_f32_u32 v226, v226
v_and_b32 v224, 1, v3
v_mul_f32 v226, 0x3d800000, v226
v_mul_u32_u24 v224, 0x8000, v224
v_mov_b32 v216, v226
v_fmamk_f32 v217, v225, 0x3c800000, v226
v_fmamk_f32 v218, v225, 0x3d000000, v226
v_fmamk_f32 v219, v225, 0x3d400000, v226
v_fmamk_f32 v220, v225, 0x3e800000, v226
v_fmamk_f32 v221, v225, 0x3e880000, v226
v_fmamk_f32 v222, v225, 0x3e900000, v226
v_fmamk_f32 v223, v225, 0x3e980000, v226
v_lshl_or_b32 v224, v224, 16, v224
v_cos_f32 v208, v216
v_sin_f32 v216, v216
v_cos_f32 v209, v217
v_sin_f32 v217, v217
v_cos_f32 v210, v218
v_sin_f32 v218, v218
v_cos_f32 v211, v219
v_sin_f32 v219, v219
v_cos_f32 v212, v220
v_sin_f32 v220, v220
v_cos_f32 v213, v221
v_sin_f32 v221, v221
v_cos_f32 v214, v222
v_sin_f32 v222, v222
v_cos_f32 v215, v223
v_sin_f32 v223, v223
v_cvt_pk_bf16_f32 v16, -v216, -v217
v_cvt_pk_bf16_f32 v17, -v218, -v219
v_cvt_pk_bf16_f32 v18, v208, v209
v_cvt_pk_bf16_f32 v19, v210, v211
v_cvt_pk_bf16_f32 v20, v216, v217
v_cvt_pk_bf16_f32 v21, v218, v219
v_xor_b32 v28, v224, v16
v_xor_b32 v29, v224, v17
v_xor_b32 v30, v224, v18
v_xor_b32 v31, v224, v19
v_xor_b32 v32, v224, v20
v_xor_b32 v33, v224, v21
v_cvt_pk_bf16_f32 v22, -v220, -v221
v_cvt_pk_bf16_f32 v23, -v222, -v223
v_cvt_pk_bf16_f32 v24, v212, v213
v_cvt_pk_bf16_f32 v25, v214, v215
v_cvt_pk_bf16_f32 v26, v220, v221
v_cvt_pk_bf16_f32 v27, v222, v223
v_xor_b32 v34, v224, v22
v_xor_b32 v35, v224, v23
v_xor_b32 v36, v224, v24
v_xor_b32 v37, v224, v25
v_xor_b32 v38, v224, v26
v_xor_b32 v39, v224, v27
v_cvt_pk_bf16_f32 v40, -v216, -v209
v_cvt_pk_bf16_f32 v41, v218, v211
v_cvt_pk_bf16_f32 v42, v208, -v217
v_cvt_pk_bf16_f32 v43, -v210, v219
v_cvt_pk_bf16_f32 v44, v216, v209
v_cvt_pk_bf16_f32 v45, -v218, -v211
v_xor_b32 v52, v224, v40
v_xor_b32 v53, v224, v41
v_xor_b32 v54, v224, v42
v_xor_b32 v55, v224, v43
v_xor_b32 v56, v224, v44
v_xor_b32 v57, v224, v45
v_cvt_pk_bf16_f32 v46, -v220, -v213
v_cvt_pk_bf16_f32 v47, v222, v215
v_cvt_pk_bf16_f32 v48, v212, -v221
v_cvt_pk_bf16_f32 v49, -v214, v223
v_cvt_pk_bf16_f32 v50, v220, v213
v_cvt_pk_bf16_f32 v51, -v222, -v215
v_xor_b32 v58, v224, v46
v_xor_b32 v59, v224, v47
v_xor_b32 v60, v224, v48
v_xor_b32 v61, v224, v49
v_xor_b32 v62, v224, v50
v_xor_b32 v63, v224, v51
v_cvt_pk_bf16_f32 v64, -v216, v217
v_cvt_pk_bf16_f32 v65, -v218, v219
v_cvt_pk_bf16_f32 v66, v208, -v209
v_cvt_pk_bf16_f32 v67, v210, -v211
v_cvt_pk_bf16_f32 v68, v216, -v217
v_cvt_pk_bf16_f32 v69, v218, -v219
v_xor_b32 v76, v224, v64
v_xor_b32 v77, v224, v65
v_xor_b32 v78, v224, v66
v_xor_b32 v79, v224, v67
v_xor_b32 v80, v224, v68
v_xor_b32 v81, v224, v69
v_cvt_pk_bf16_f32 v70, -v220, v221
v_cvt_pk_bf16_f32 v71, -v222, v223
v_cvt_pk_bf16_f32 v72, v212, -v213
v_cvt_pk_bf16_f32 v73, v214, -v215
v_cvt_pk_bf16_f32 v74, v220, -v221
v_cvt_pk_bf16_f32 v75, v222, -v223
v_xor_b32 v82, v224, v70
v_xor_b32 v83, v224, v71
v_xor_b32 v84, v224, v72
v_xor_b32 v85, v224, v73
v_xor_b32 v86, v224, v74
v_xor_b32 v87, v224, v75
v_cvt_pk_bf16_f32 v88, -v216, v209
v_cvt_pk_bf16_f32 v89, v218, -v211
v_cvt_pk_bf16_f32 v90, v208, v217
v_cvt_pk_bf16_f32 v91, -v210, -v219
v_cvt_pk_bf16_f32 v92, v216, -v209
v_cvt_pk_bf16_f32 v93, -v218, v211
v_xor_b32 v100, v224, v88
v_xor_b32 v101, v224, v89
v_xor_b32 v102, v224, v90
v_xor_b32 v103, v224, v91
v_xor_b32 v104, v224, v92
v_xor_b32 v105, v224, v93
v_cvt_pk_bf16_f32 v94, -v220, v213
v_cvt_pk_bf16_f32 v95, v222, -v215
v_cvt_pk_bf16_f32 v96, v212, v221
v_cvt_pk_bf16_f32 v97, -v214, -v223
v_cvt_pk_bf16_f32 v98, v220, -v213
v_cvt_pk_bf16_f32 v99, -v222, v215
v_xor_b32 v106, v224, v94
v_xor_b32 v107, v224, v95
v_xor_b32 v108, v224, v96
v_xor_b32 v109, v224, v97
v_xor_b32 v110, v224, v98
v_xor_b32 v111, v224, v99
s_cmp_eq_u32 s27, 20
s_nop 0
s_cbranch_scc1 k1_r2
k1_r1:
s_waitcnt vmcnt(1)
ds_read_u16_d16_hi v112, v9 offset:0
ds_read_u16_d16_hi v113, v9 offset:48
ds_read_u16_d16_hi v114, v9 offset:96
ds_read_u16_d16_hi v115, v9 offset:144
ds_read_u16_d16_hi v128, v9 offset:3072
ds_read_u16_d16_hi v129, v9 offset:3120
ds_read_u16_d16_hi v130, v9 offset:3168
ds_read_u16_d16_hi v131, v9 offset:3216
ds_read_u16_d16_hi v116, v9 offset:768
ds_read_u16_d16_hi v117, v9 offset:816
ds_read_u16_d16_hi v118, v9 offset:864
ds_read_u16_d16_hi v119, v9 offset:912
ds_read_u16_d16_hi v132, v9 offset:3840
ds_read_u16_d16_hi v133, v9 offset:3888
ds_read_u16_d16_hi v134, v9 offset:3936
ds_read_u16_d16_hi v135, v9 offset:3984
ds_read_u16_d16_hi v120, v9 offset:1536
ds_read_u16_d16_hi v121, v9 offset:1584
ds_read_u16_d16_hi v122, v9 offset:1632
ds_read_u16_d16_hi v123, v9 offset:1680
ds_read_u16_d16_hi v136, v9 offset:4608
ds_read_u16_d16_hi v137, v9 offset:4656
ds_read_u16_d16_hi v138, v9 offset:4704
ds_read_u16_d16_hi v139, v9 offset:4752
ds_read_u16_d16_hi v124, v9 offset:2304
ds_read_u16_d16_hi v125, v9 offset:2352
ds_read_u16_d16_hi v126, v9 offset:2400
ds_read_u16_d16_hi v127, v9 offset:2448
ds_read_u16_d16_hi v140, v9 offset:5376
ds_read_u16_d16_hi v141, v9 offset:5424
ds_read_u16_d16_hi v142, v9 offset:5472
ds_read_u16_d16_hi v143, v9 offset:5520
s_cmp_lg_u32 s22, 0
s_cbranch_scc1 k1_rp1
s_mov_b32 s52, 0
k1_tk3:
s_waitcnt vmcnt(0)
v_readfirstlane_b32 s50, v252
v_readfirstlane_b32 s51, v253
s_add_u32 s52, s52, 1
s_xor_b32 s53, s50, s51
s_cmp_eq_u32 s53, -1
s_nop 1
s_cbranch_scc1 k1_tk4
buffer_load_dwordx2 v[252:253], off, s[64:67], 0 sc1
s_cmp_lt_u32 s52, 32768
s_cbranch_scc1 k1_tk3
k1_tk4:
s_mov_b32 s52, 0
k1_pl5:
buffer_load_dwordx2 v[240:241], v250, s[16:19], s41 offen sc1
s_add_u32 s52, s52, 1
s_waitcnt vmcnt(0)
v_cmp_ne_u64 vcc, s[50:51], v[240:241]
s_nop 4
s_cbranch_vccz k1_pl6
s_sleep 1
s_cmp_lt_u32 s52, 32768
s_cbranch_scc1 k1_pl5
k1_pl6:
v_mov_b32 v252, 1
ds_write_b32 v251, v252 offset:4
s_nop 0
s_branch k1_rp2
k1_rp1:
s_waitcnt vmcnt(0)
s_mov_b32 s52, 0
k1_lw7:
ds_read_b32 v252, v251 offset:4
s_add_u32 s52, s52, 1
s_waitcnt lgkmcnt(0)
v_readfirstlane_b32 s53, v252
s_cmp_ge_u32 s53, 1
s_nop 3
s_cbranch_scc1 k1_lw8
s_sleep 1
s_cmp_lt_u32 s52, 524288
s_cbranch_scc1 k1_lw7
k1_lw8:
k1_rp2:
buffer_load_dwordx4 v[144:147], v11, s[16:19], s37 offen offset:0 sc1
buffer_load_dwordx4 v[148:151], v11, s[16:19], s37 offen offset:1024 sc1
buffer_load_dwordx4 v[152:155], v11, s[16:19], s37 offen offset:2048 sc1
buffer_load_dwordx4 v[156:159], v11, s[16:19], s37 offen offset:3072 sc1
s_waitcnt lgkmcnt(0)
s_waitcnt vmcnt(3)
v_mfma_f32_16x16x32_bf16 v[160:163], v[18:21], v[144:147], 0
v_mfma_f32_16x16x32_bf16 v[176:179], v[16:19], v[144:147], 0
s_waitcnt vmcnt(2)
v_mfma_f32_16x16x32_bf16 v[160:163], v[24:27], v[148:151], v[160:163]
v_mfma_f32_16x16x32_bf16 v[176:179], v[22:25], v[148:151], v[176:179]
s_waitcnt vmcnt(1)
v_mfma_f32_16x16x32_bf16 v[160:163], v[30:33], v[152:155], v[160:163]
v_mfma_f32_16x16x32_bf16 v[176:179], v[28:31], v[152:155], v[176:179]
s_waitcnt vmcnt(0)
v_mfma_f32_16x16x32_bf16 v[160:163], v[36:39], v[156:159], v[160:163]
v_mfma_f32_16x16x32_bf16 v[176:179], v[34:37], v[156:159], v[176:179]
v_mfma_f32_16x16x32_bf16 v[164:167], v[42:45], v[144:147], 0
v_mfma_f32_16x16x32_bf16 v[180:183], v[40:43], v[144:147], 0
v_mfma_f32_16x16x32_bf16 v[164:167], v[48:51], v[148:151], v[164:167]
s_nop 4
v_pk_mul_f32 v[240:241], v[176:177], v[128:129]
v_pk_mul_f32 v[176:177], v[176:177], v[112:113]
v_mfma_f32_16x16x32_bf16 v[180:183], v[46:49], v[148:151], v[180:183]
v_pk_mul_f32 v[242:243], v[178:179], v[130:131]
v_pk_mul_f32 v[178:179], v[178:179], v[114:115]
v_mfma_f32_16x16x32_bf16 v[164:167], v[54:57], v[152:155], v[164:167]
v_pk_fma_f32 v[240:241], v[160:161], v[112:113], v[240:241] neg_lo:[0,0,1] neg_hi:[0,0,1]
v_pk_fma_f32 v[176:177], v[160:161], v[128:129], v[176:177]
v_mfma_f32_16x16x32_bf16 v[180:183], v[52:55], v[152:155], v[180:183]
v_pk_fma_f32 v[242:243], v[162:163], v[114:115], v[242:243] neg_lo:[0,0,1] neg_hi:[0,0,1]
v_pk_fma_f32 v[178:179], v[162:163], v[130:131], v[178:179]
v_mfma_f32_16x16x32_bf16 v[164:167], v[60:63], v[156:159], v[164:167]
v_cvt_pk_bf16_f32 v192, v240, v241
v_cvt_pk_bf16_f32 v194, -v176, -v177
v_mfma_f32_16x16x32_bf16 v[180:183], v[58:61], v[156:159], v[180:183]
v_cvt_pk_bf16_f32 v193, v242, v243
v_cvt_pk_bf16_f32 v195, -v178, -v179
v_mfma_f32_16x16x32_bf16 v[168:171], v[66:69], v[144:147], 0
v_mfma_f32_16x16x32_bf16 v[184:187], v[64:67], v[144:147], 0
v_mfma_f32_16x16x32_bf16 v[168:171], v[72:75], v[148:151], v[168:171]
s_nop 2
v_pk_mul_f32 v[240:241], v[180:181], v[132:133]
v_pk_mul_f32 v[180:181], v[180:181], v[116:117]
v_mfma_f32_16x16x32_bf16 v[184:187], v[70:73], v[148:151], v[184:187]
v_pk_mul_f32 v[242:243], v[182:183], v[134:135]
v_pk_mul_f32 v[182:183], v[182:183], v[118:119]
v_mfma_f32_16x16x32_bf16 v[168:171], v[78:81], v[152:155], v[168:171]
v_pk_fma_f32 v[240:241], v[164:165], v[116:117], v[240:241] neg_lo:[0,0,1] neg_hi:[0,0,1]
v_pk_fma_f32 v[180:181], v[164:165], v[132:133], v[180:181]
v_mfma_f32_16x16x32_bf16 v[184:187], v[76:79], v[152:155], v[184:187]
v_pk_fma_f32 v[242:243], v[166:167], v[118:119], v[242:243] neg_lo:[0,0,1] neg_hi:[0,0,1]
v_pk_fma_f32 v[182:183], v[166:167], v[134:135], v[182:183]
v_mfma_f32_16x16x32_bf16 v[168:171], v[84:87], v[156:159], v[168:171]
v_cvt_pk_bf16_f32 v196, v240, v241
v_cvt_pk_bf16_f32 v198, -v180, -v181
v_mfma_f32_16x16x32_bf16 v[184:187], v[82:85], v[156:159], v[184:187]
v_cvt_pk_bf16_f32 v197, v242, v243
v_cvt_pk_bf16_f32 v199, -v182, -v183
v_mfma_f32_16x16x32_bf16 v[172:175], v[90:93], v[144:147], 0
v_mfma_f32_16x16x32_bf16 v[188:191], v[88:91], v[144:147], 0
v_mfma_f32_16x16x32_bf16 v[172:175], v[96:99], v[148:151], v[172:175]
s_nop 2
v_pk_mul_f32 v[240:241], v[184:185], v[136:137]
v_pk_mul_f32 v[184:185], v[184:185], v[120:121]
v_mfma_f32_16x16x32_bf16 v[188:191], v[94:97], v[148:151], v[188:191]
v_pk_mul_f32 v[242:243], v[186:187], v[138:139]
v_pk_mul_f32 v[186:187], v[186:187], v[122:123]
v_mfma_f32_16x16x32_bf16 v[172:175], v[102:105], v[152:155], v[172:175]
v_pk_fma_f32 v[240:241], v[168:169], v[120:121], v[240:241] neg_lo:[0,0,1] neg_hi:[0,0,1]
v_pk_fma_f32 v[184:185], v[168:169], v[136:137], v[184:185]
v_mfma_f32_16x16x32_bf16 v[188:191], v[100:103], v[152:155], v[188:191]
v_pk_fma_f32 v[242:243], v[170:171], v[122:123], v[242:243] neg_lo:[0,0,1] neg_hi:[0,0,1]
v_pk_fma_f32 v[186:187], v[170:171], v[138:139], v[186:187]
v_mfma_f32_16x16x32_bf16 v[172:175], v[108:111], v[156:159], v[172:175]
v_cvt_pk_bf16_f32 v200, v240, v241
v_cvt_pk_bf16_f32 v202, -v184, -v185
v_mfma_f32_16x16x32_bf16 v[188:191], v[106:109], v[156:159], v[188:191]
v_cvt_pk_bf16_f32 v201, v242, v243
v_cvt_pk_bf16_f32 v203, -v186, -v187
v_mfma_f32_16x16x32_bf16 v[208:211], v[192:195], v[18:21], 0
v_mfma_f32_16x16x32_bf16 v[212:215], v[192:195], v[16:19], 0
v_mfma_f32_16x16x32_bf16 v[216:219], v[192:195], v[42:45], 0
s_nop 2
v_pk_mul_f32 v[240:241], v[188:189], v[140:141]
v_pk_mul_f32 v[188:189], v[188:189], v[124:125]
v_mfma_f32_16x16x32_bf16 v[220:223], v[192:195], v[40:43], 0
v_pk_mul_f32 v[242:243], v[190:191], v[142:143]
v_pk_mul_f32 v[190:191], v[190:191], v[126:127]
v_mfma_f32_16x16x32_bf16 v[224:227], v[192:195], v[66:69], 0
v_pk_fma_f32 v[240:241], v[172:173], v[124:125], v[240:241] neg_lo:[0,0,1] neg_hi:[0,0,1]
v_pk_fma_f32 v[188:189], v[172:173], v[140:141], v[188:189]
v_mfma_f32_16x16x32_bf16 v[228:231], v[192:195], v[64:67], 0
v_pk_fma_f32 v[242:243], v[174:175], v[126:127], v[242:243] neg_lo:[0,0,1] neg_hi:[0,0,1]
v_pk_fma_f32 v[190:191], v[174:175], v[142:143], v[190:191]
v_mfma_f32_16x16x32_bf16 v[232:235], v[192:195], v[90:93], 0
v_cvt_pk_bf16_f32 v204, v240, v241
v_cvt_pk_bf16_f32 v206, -v188, -v189
v_mfma_f32_16x16x32_bf16 v[236:239], v[192:195], v[88:91], 0
v_cvt_pk_bf16_f32 v205, v242, v243
v_cvt_pk_bf16_f32 v207, -v190, -v191
v_mfma_f32_16x16x32_bf16 v[208:211], v[196:199], v[24:27], v[208:211]
v_mfma_f32_16x16x32_bf16 v[212:215], v[196:199], v[22:25], v[212:215]
v_mfma_f32_16x16x32_bf16 v[216:219], v[196:199], v[48:51], v[216:219]
v_mfma_f32_16x16x32_bf16 v[220:223], v[196:199], v[46:49], v[220:223]
v_mfma_f32_16x16x32_bf16 v[224:227], v[196:199], v[72:75], v[224:227]
v_mfma_f32_16x16x32_bf16 v[228:231], v[196:199], v[70:73], v[228:231]
v_mfma_f32_16x16x32_bf16 v[232:235], v[196:199], v[96:99], v[232:235]
v_mfma_f32_16x16x32_bf16 v[236:239], v[196:199], v[94:97], v[236:239]
v_mfma_f32_16x16x32_bf16 v[208:211], v[200:203], v[30:33], v[208:211]
v_mfma_f32_16x16x32_bf16 v[212:215], v[200:203], v[28:31], v[212:215]
v_mfma_f32_16x16x32_bf16 v[216:219], v[200:203], v[54:57], v[216:219]
v_mfma_f32_16x16x32_bf16 v[220:223], v[200:203], v[52:55], v[220:223]
v_mfma_f32_16x16x32_bf16 v[224:227], v[200:203], v[78:81], v[224:227]
v_mfma_f32_16x16x32_bf16 v[228:231], v[200:203], v[76:79], v[228:231]
v_mfma_f32_16x16x32_bf16 v[232:235], v[200:203], v[102:105], v[232:235]
v_mfma_f32_16x16x32_bf16 v[236:239], v[200:203], v[100:103], v[236:239]
v_mfma_f32_16x16x32_bf16 v[208:211], v[204:207], v[36:39], v[208:211]
v_mfma_f32_16x16x32_bf16 v[212:215], v[204:207], v[34:37], v[212:215]
v_mfma_f32_16x16x32_bf16 v[216:219], v[204:207], v[60:63], v[216:219]
v_mfma_f32_16x16x32_bf16 v[220:223], v[204:207], v[58:61], v[220:223]
v_mfma_f32_16x16x32_bf16 v[224:227], v[204:207], v[84:87], v[224:227]
s_nop 3
v_cvt_pk_bf16_f32 v160, v208, v209
v_cvt_pk_bf16_f32 v161, v210, v211
v_cvt_pk_bf16_f32 v162, -v212, -v213
v_mfma_f32_16x16x32_bf16 v[228:231], v[204:207], v[82:85], v[228:231]
v_cvt_pk_bf16_f32 v163, -v214, -v215
ds_write_b128 v15, v[160:163] offset:0
ds_read_b128 v[176:179], v249 offset:0
v_mfma_f32_16x16x32_bf16 v[232:235], v[204:207], v[108:111], v[232:235]
v_cvt_pk_bf16_f32 v164, v216, v217
v_cvt_pk_bf16_f32 v165, v218, v219
v_cvt_pk_bf16_f32 v166, -v220, -v221
v_mfma_f32_16x16x32_bf16 v[236:239], v[204:207], v[106:109], v[236:239]
v_cvt_pk_bf16_f32 v167, -v222, -v223
ds_write_b128 v15, v[164:167] offset:1024
ds_read_b128 v[180:183], v249 offset:1024
s_waitcnt lgkmcnt(2)
buffer_store_dwordx4 v[176:179], v10, s[16:19], s40 offen sc1
s_add_u32 s40, s40, 655360
v_cvt_pk_bf16_f32 v168, v224, v225
v_cvt_pk_bf16_f32 v169, v226, v227
v_cvt_pk_bf16_f32 v170, -v228, -v229
v_cvt_pk_bf16_f32 v171, -v230, -v231
ds_write_b128 v15, v[168:171] offset:2048
ds_read_b128 v[184:187], v249 offset:2048
s_waitcnt lgkmcnt(2)
buffer_store_dwordx4 v[180:183], v10, s[16:19], s40 offen sc1
s_add_u32 s40, s40, 655360
v_cvt_pk_bf16_f32 v172, v232, v233
v_cvt_pk_bf16_f32 v173, v234, v235
v_cvt_pk_bf16_f32 v174, -v236, -v237
v_cvt_pk_bf16_f32 v175, -v238, -v239
ds_write_b128 v15, v[172:175] offset:3072
ds_read_b128 v[188:191], v249 offset:3072
s_waitcnt lgkmcnt(2)
buffer_store_dwordx4 v[184:187], v10, s[16:19], s40 offen sc1
s_add_u32 s40, s40, 655360
s_waitcnt lgkmcnt(0)
buffer_store_dwordx4 v[188:191], v10, s[16:19], s40 offen sc1
s_endpgm
k1_r2:
v_lshlrev_b32 v8, 9, v2
s_lshl_b32 s37, s28, 4
s_add_u32 s40, s37, 12124160
s_add_u32 s37, s37, 12058624
v_lshlrev_b32 v10, 9, v3
v_add_u32 v9, 8192, v10
s_add_u32 s42, s40, 16384
s_cmp_lg_u32 s22, 0
s_cbranch_scc1 k1_rp9
s_mov_b32 s52, 0
k1_tk11:
s_waitcnt vmcnt(0)
v_readfirstlane_b32 s50, v252
v_readfirstlane_b32 s51, v253
s_add_u32 s52, s52, 1
s_xor_b32 s53, s50, s51
s_cmp_eq_u32 s53, -1
s_nop 1
s_cbranch_scc1 k1_tk12
buffer_load_dwordx2 v[252:253], off, s[64:67], 0 sc1
s_cmp_lt_u32 s52, 32768
s_cbranch_scc1 k1_tk11
k1_tk12:
s_mov_b32 s52, 0
k1_pl13:
buffer_load_dwordx2 v[240:241], v250, s[16:19], s41 offen sc1
s_add_u32 s52, s52, 1
s_waitcnt vmcnt(0)
v_cmp_ne_u64 vcc, s[50:51], v[240:241]
s_nop 4
s_cbranch_vccz k1_pl14
s_sleep 1
s_cmp_lt_u32 s52, 32768
s_cbranch_scc1 k1_pl13
k1_pl14:
v_mov_b32 v252, 1
ds_write_b32 v251, v252 offset:4
s_nop 0
s_branch k1_rp10
k1_rp9:
s_waitcnt vmcnt(0)
s_mov_b32 s52, 0
k1_lw15:
ds_read_b32 v252, v251 offset:4
s_add_u32 s52, s52, 1
s_waitcnt lgkmcnt(0)
v_readfirstlane_b32 s53, v252
s_cmp_ge_u32 s53, 1
s_nop 3
s_cbranch_scc1 k1_lw16
s_sleep 1
s_cmp_lt_u32 s52, 524288
s_cbranch_scc1 k1_lw15
k1_lw16:
k1_rp10:
buffer_load_dwordx4 v[144:147], v8, s[16:19], s37 offen offset:0 sc1
buffer_load_dwordx4 v[148:151], v8, s[16:19], s37 offen offset:2048 sc1
s_add_u32 s37, s37, 4096
buffer_load_dwordx4 v[152:155], v8, s[16:19], s37 offen offset:0 sc1
buffer_load_dwordx4 v[156:159], v8, s[16:19], s37 offen offset:2048 sc1
s_waitcnt lgkmcnt(0)
s_waitcnt vmcnt(3)
v_mfma_f32_16x16x32_bf16 v[160:163], v[18:21], v[144:147], 0
v_mfma_f32_16x16x32_bf16 v[176:179], v[16:19], v[144:147], 0
s_waitcnt vmcnt(2)
v_mfma_f32_16x16x32_bf16 v[160:163], v[24:27], v[148:151], v[160:163]
v_mfma_f32_16x16x32_bf16 v[176:179], v[22:25], v[148:151], v[176:179]
s_waitcnt vmcnt(1)
v_mfma_f32_16x16x32_bf16 v[160:163], v[30:33], v[152:155], v[160:163]
v_mfma_f32_16x16x32_bf16 v[176:179], v[28:31], v[152:155], v[176:179]
s_waitcnt vmcnt(0)
v_mfma_f32_16x16x32_bf16 v[160:163], v[36:39], v[156:159], v[160:163]
v_mfma_f32_16x16x32_bf16 v[176:179], v[34:37], v[156:159], v[176:179]
v_mfma_f32_16x16x32_bf16 v[164:167], v[42:45], v[144:147], 0
v_mfma_f32_16x16x32_bf16 v[180:183], v[40:43], v[144:147], 0
v_mfma_f32_16x16x32_bf16 v[164:167], v[48:51], v[148:151], v[164:167]
s_nop 4
v_pk_mul_f32 v[240:241], v[176:177], v[128:129]
v_pk_mul_f32 v[176:177], v[176:177], v[112:113]
v_mfma_f32_16x16x32_bf16 v[180:183], v[46:49], v[148:151], v[180:183]
v_pk_mul_f32 v[242:243], v[178:179], v[130:131]
v_pk_mul_f32 v[178:179], v[178:179], v[114:115]
v_mfma_f32_16x16x32_bf16 v[164:167], v[54:57], v[152:155], v[164:167]
v_pk_fma_f32 v[240:241], v[160:161], v[112:113], v[240:241] neg_lo:[0,0,1] neg_hi:[0,0,1]
v_pk_fma_f32 v[176:177], v[160:161], v[128:129], v[176:177]
v_mfma_f32_16x16x32_bf16 v[180:183], v[52:55], v[152:155], v[180:183]
v_pk_fma_f32 v[242:243], v[162:163], v[114:115], v[242:243] neg_lo:[0,0,1] neg_hi:[0,0,1]
v_pk_fma_f32 v[178:179], v[162:163], v[130:131], v[178:179]
v_mfma_f32_16x16x32_bf16 v[164:167], v[60:63], v[156:159], v[164:167]
v_cvt_pk_bf16_f32 v192, v240, v241
v_cvt_pk_bf16_f32 v194, -v176, -v177
v_mfma_f32_16x16x32_bf16 v[180:183], v[58:61], v[156:159], v[180:183]
v_cvt_pk_bf16_f32 v193, v242, v243
v_cvt_pk_bf16_f32 v195, -v178, -v179
v_mfma_f32_16x16x32_bf16 v[168:171], v[66:69], v[144:147], 0
v_mfma_f32_16x16x32_bf16 v[184:187], v[64:67], v[144:147], 0
v_mfma_f32_16x16x32_bf16 v[168:171], v[72:75], v[148:151], v[168:171]
s_nop 2
v_pk_mul_f32 v[240:241], v[180:181], v[132:133]
v_pk_mul_f32 v[180:181], v[180:181], v[116:117]
v_mfma_f32_16x16x32_bf16 v[184:187], v[70:73], v[148:151], v[184:187]
v_pk_mul_f32 v[242:243], v[182:183], v[134:135]
v_pk_mul_f32 v[182:183], v[182:183], v[118:119]
v_mfma_f32_16x16x32_bf16 v[168:171], v[78:81], v[152:155], v[168:171]
v_pk_fma_f32 v[240:241], v[164:165], v[116:117], v[240:241] neg_lo:[0,0,1] neg_hi:[0,0,1]
v_pk_fma_f32 v[180:181], v[164:165], v[132:133], v[180:181]
v_mfma_f32_16x16x32_bf16 v[184:187], v[76:79], v[152:155], v[184:187]
v_pk_fma_f32 v[242:243], v[166:167], v[118:119], v[242:243] neg_lo:[0,0,1] neg_hi:[0,0,1]
v_pk_fma_f32 v[182:183], v[166:167], v[134:135], v[182:183]
v_mfma_f32_16x16x32_bf16 v[168:171], v[84:87], v[156:159], v[168:171]
v_cvt_pk_bf16_f32 v196, v240, v241
v_cvt_pk_bf16_f32 v198, -v180, -v181
v_mfma_f32_16x16x32_bf16 v[184:187], v[82:85], v[156:159], v[184:187]
v_cvt_pk_bf16_f32 v197, v242, v243
v_cvt_pk_bf16_f32 v199, -v182, -v183
v_mfma_f32_16x16x32_bf16 v[172:175], v[90:93], v[144:147], 0
v_mfma_f32_16x16x32_bf16 v[188:191], v[88:91], v[144:147], 0
v_mfma_f32_16x16x32_bf16 v[172:175], v[96:99], v[148:151], v[172:175]
s_nop 2
v_pk_mul_f32 v[240:241], v[184:185], v[136:137]
v_pk_mul_f32 v[184:185], v[184:185], v[120:121]
v_mfma_f32_16x16x32_bf16 v[188:191], v[94:97], v[148:151], v[188:191]
v_pk_mul_f32 v[242:243], v[186:187], v[138:139]
v_pk_mul_f32 v[186:187], v[186:187], v[122:123]
v_mfma_f32_16x16x32_bf16 v[172:175], v[102:105], v[152:155], v[172:175]
v_pk_fma_f32 v[240:241], v[168:169], v[120:121], v[240:241] neg_lo:[0,0,1] neg_hi:[0,0,1]
v_pk_fma_f32 v[184:185], v[168:169], v[136:137], v[184:185]
v_mfma_f32_16x16x32_bf16 v[188:191], v[100:103], v[152:155], v[188:191]
v_pk_fma_f32 v[242:243], v[170:171], v[122:123], v[242:243] neg_lo:[0,0,1] neg_hi:[0,0,1]
v_pk_fma_f32 v[186:187], v[170:171], v[138:139], v[186:187]
v_mfma_f32_16x16x32_bf16 v[172:175], v[108:111], v[156:159], v[172:175]
v_cvt_pk_bf16_f32 v200, v240, v241
v_cvt_pk_bf16_f32 v202, -v184, -v185
v_mfma_f32_16x16x32_bf16 v[188:191], v[106:109], v[156:159], v[188:191]
v_cvt_pk_bf16_f32 v201, v242, v243
v_cvt_pk_bf16_f32 v203, -v186, -v187
v_mfma_f32_16x16x32_bf16 v[208:211], v[192:195], v[18:21], 0
v_mfma_f32_16x16x32_bf16 v[212:215], v[192:195], v[16:19], 0
v_mfma_f32_16x16x32_bf16 v[216:219], v[192:195], v[42:45], 0
s_nop 2
v_pk_mul_f32 v[240:241], v[188:189], v[140:141]
v_pk_mul_f32 v[188:189], v[188:189], v[124:125]
v_mfma_f32_16x16x32_bf16 v[220:223], v[192:195], v[40:43], 0
v_pk_mul_f32 v[242:243], v[190:191], v[142:143]
v_pk_mul_f32 v[190:191], v[190:191], v[126:127]
v_mfma_f32_16x16x32_bf16 v[224:227], v[192:195], v[66:69], 0
v_pk_fma_f32 v[240:241], v[172:173], v[124:125], v[240:241] neg_lo:[0,0,1] neg_hi:[0,0,1]
v_pk_fma_f32 v[188:189], v[172:173], v[140:141], v[188:189]
v_mfma_f32_16x16x32_bf16 v[228:231], v[192:195], v[64:67], 0
v_pk_fma_f32 v[242:243], v[174:175], v[126:127], v[242:243] neg_lo:[0,0,1] neg_hi:[0,0,1]
v_pk_fma_f32 v[190:191], v[174:175], v[142:143], v[190:191]
v_mfma_f32_16x16x32_bf16 v[232:235], v[192:195], v[90:93], 0
v_cvt_pk_bf16_f32 v204, v240, v241
v_cvt_pk_bf16_f32 v206, -v188, -v189
v_mfma_f32_16x16x32_bf16 v[236:239], v[192:195], v[88:91], 0
v_cvt_pk_bf16_f32 v205, v242, v243
v_cvt_pk_bf16_f32 v207, -v190, -v191
v_mfma_f32_16x16x32_bf16 v[208:211], v[196:199], v[24:27], v[208:211]
v_mfma_f32_16x16x32_bf16 v[212:215], v[196:199], v[22:25], v[212:215]
v_mfma_f32_16x16x32_bf16 v[216:219], v[196:199], v[48:51], v[216:219]
v_mfma_f32_16x16x32_bf16 v[220:223], v[196:199], v[46:49], v[220:223]
v_mfma_f32_16x16x32_bf16 v[224:227], v[196:199], v[72:75], v[224:227]
v_mfma_f32_16x16x32_bf16 v[228:231], v[196:199], v[70:73], v[228:231]
v_mfma_f32_16x16x32_bf16 v[232:235], v[196:199], v[96:99], v[232:235]
v_mfma_f32_16x16x32_bf16 v[236:239], v[196:199], v[94:97], v[236:239]
v_mfma_f32_16x16x32_bf16 v[208:211], v[200:203], v[30:33], v[208:211]
v_mfma_f32_16x16x32_bf16 v[212:215], v[200:203], v[28:31], v[212:215]
v_mfma_f32_16x16x32_bf16 v[216:219], v[200:203], v[54:57], v[216:219]
v_mfma_f32_16x16x32_bf16 v[220:223], v[200:203], v[52:55], v[220:223]
v_mfma_f32_16x16x32_bf16 v[224:227], v[200:203], v[78:81], v[224:227]
v_mfma_f32_16x16x32_bf16 v[228:231], v[200:203], v[76:79], v[228:231]
v_mfma_f32_16x16x32_bf16 v[232:235], v[200:203], v[102:105], v[232:235]
v_mfma_f32_16x16x32_bf16 v[236:239], v[200:203], v[100:103], v[236:239]
v_mfma_f32_16x16x32_bf16 v[208:211], v[204:207], v[36:39], v[208:211]
v_mfma_f32_16x16x32_bf16 v[212:215], v[204:207], v[34:37], v[212:215]
v_mfma_f32_16x16x32_bf16 v[216:219], v[204:207], v[60:63], v[216:219]
v_mfma_f32_16x16x32_bf16 v[220:223], v[204:207], v[58:61], v[220:223]
v_mfma_f32_16x16x32_bf16 v[224:227], v[204:207], v[84:87], v[224:227]
s_nop 3
v_cvt_pk_bf16_f32 v160, v208, v209
v_cvt_pk_bf16_f32 v161, v210, v211
v_cvt_pk_bf16_f32 v162, v212, v213
v_mfma_f32_16x16x32_bf16 v[228:231], v[204:207], v[82:85], v[228:231]
v_cvt_pk_bf16_f32 v163, v214, v215
v_mfma_f32_16x16x32_bf16 v[232:235], v[204:207], v[108:111], v[232:235]
v_cvt_pk_bf16_f32 v164, v216, v217
v_cvt_pk_bf16_f32 v165, v218, v219
v_cvt_pk_bf16_f32 v166, v220, v221
v_mfma_f32_16x16x32_bf16 v[236:239], v[204:207], v[106:109], v[236:239]
v_cvt_pk_bf16_f32 v167, v222, v223
v_cvt_pk_bf16_f32 v168, v224, v225
v_cvt_pk_bf16_f32 v169, v226, v227
v_cvt_pk_bf16_f32 v170, v228, v229
v_cvt_pk_bf16_f32 v171, v230, v231
v_cvt_pk_bf16_f32 v172, v232, v233
v_cvt_pk_bf16_f32 v173, v234, v235
s_nop 0
v_cvt_pk_bf16_f32 v174, v236, v237
v_cvt_pk_bf16_f32 v175, v238, v239
s_mov_b64 exec, 0xffff
buffer_store_dwordx4 v[160:163], v10, s[16:19], s40 offen sc1
buffer_store_dwordx4 v[164:167], v9, s[16:19], s40 offen sc1
buffer_store_dwordx4 v[168:171], v10, s[16:19], s42 offen sc1
buffer_store_dwordx4 v[172:175], v9, s[16:19], s42 offen sc1
s_endpgm
k1_pnone:
s_waitcnt vmcnt(0)
s_barrier
s_lshl_b32 s37, s33, 2
s_add_u32 s37, s37, s22
s_getpc_b64 s[4:5]
s_add_u32 s4, s4, k3_kernel@rel32@lo+4
s_addc_u32 s5, s5, k3_kernel@rel32@hi+12
s_mov_b32 s6, code_end-k3_kernel
s_mov_b32 s7, 0x00020000
s_lshl_b32 s37, s37, 12
v_lshlrev_b32 v12, 6, v1
buffer_load_dword v15, v12, s[4:7], s37 offen
s_barrier
s_waitcnt vmcnt(0)
s_endpgm
k1_pf:
s_add_u32 s62, s48, 49152
s_waitcnt lgkmcnt(0)
s_mov_b32 s8, s4
s_mov_b32 s9, s5
s_add_u32 m0, s61, 0
s_nop 0
buffer_load_dwordx4 v4, s[8:11], s46 offen lds
s_add_u32 m0, s61, 1024
s_nop 0
buffer_load_dwordx4 v5, s[8:11], s46 offen lds
s_add_u32 m0, s61, 2048
s_nop 0
buffer_load_dwordx4 v6, s[8:11], s46 offen lds
s_add_u32 m0, s61, 3072
s_nop 0
buffer_load_dwordx4 v7, s[8:11], s46 offen lds
s_add_u32 s46, s46, 128
s_cmp_eq_u32 s46, 1280
s_cselect_b32 s46, 0, s46
s_add_u32 s61, s61, 16384
s_cmp_eq_u32 s61, s62
s_cselect_b32 s61, s48, s61
s_add_u32 m0, s61, 0
s_nop 0
buffer_load_dwordx4 v4, s[8:11], s46 offen lds
s_add_u32 m0, s61, 1024
s_nop 0
buffer_load_dwordx4 v5, s[8:11], s46 offen lds
s_add_u32 m0, s61, 2048
s_nop 0
buffer_load_dwordx4 v6, s[8:11], s46 offen lds
s_add_u32 m0, s61, 3072
s_nop 0
buffer_load_dwordx4 v7, s[8:11], s46 offen lds
s_add_u32 s46, s46, 128
s_cmp_eq_u32 s46, 1280
s_cselect_b32 s46, 0, s46
s_add_u32 s61, s61, 16384
s_cmp_eq_u32 s61, s62
s_cselect_b32 s61, s48, s61
s_load_dwordx2 s[30:31], s[0:1], 16
s_load_dwordx4 s[4:7], s[0:1], 32
s_mov_b32 s52, 0
k1_fgen:
s_and_b32 s38, s22, 1
s_mul_i32 s39, s38, 10240
s_lshr_b32 s40, s22, 1
s_mul_i32 s41, s40, 5120
s_add_u32 s39, s39, s41
s_mul_i32 s41, s52, 20480
s_add_u32 s39, s39, s41
v_add_u32 v13, s39, v11
s_xor_b32 s38, s38, s21
s_and_b32 s38, s38, 1
s_lshl_b32 s38, s38, 5
s_add_u32 s39, s45, s52
s_lshl_b32 s39, s39, 6
s_add_u32 s38, s38, s39
v_lshl_add_u32 v9, v2, 3, s38
s_mul_i32 s41, s40, 5
s_mul_i32 s42, s21, 80
s_mov_b32 s43, 0xc4200000
s_or_b32 s38, s21, s40
s_cmp_eq_u32 s38, 0
s_cselect_b32 s50, 0x00010001, 0
s_mov_b32 s51, s50
v_mov_b32 v15, 320
s_add_u32 s38, s41, 0
s_lshr_b32 s39, s38, 1
s_lshl_b32 s39, s39, 4
s_add_u32 s39, s39, s42
s_and_b32 s38, s38, 1
s_mul_i32 s38, s38, 0x3e800000
v_add_u32 v44, s39, v3
v_mov_b32 v48, s38
v_mul_u32_u24 v45, v44, v9
v_cvt_f32_u32 v44, v44
v_cvt_f32_u32 v45, v45
v_mul_f32 v47, 0x3acccccd, v44
v_mul_f32 v46, 0x3acccccd, v45
v_cos_f32 v49, v47
v_rndne_f32 v46, v46
v_fma_f32 v45, v46, s43, v45
v_mul_f32 v46, 0x3dcccccd, v44
v_fmamk_f32 v16, v45, 0x3acccccd, v48
v_rndne_f32 v46, v46
v_add_f32 v17, v47, v16
v_fmamk_f32 v46, v46, 0xc1200000, v44
v_add_f32 v49, v49, v49
v_fmamk_f32 v24, v46, 0x3dcccccd, v16
v_fmamk_f32 v25, v46, 0x3dcccccd, v17
v_mul_f32 v46, 0x3dcccccd, v46
v_cos_f32 v16, v16
v_cos_f32 v17, v17
v_cos_f32 v24, v24
v_cos_f32 v25, v25
v_cos_f32 v50, v46
v_fma_f32 v18, v49, v17, -v16
v_fma_f32 v26, v49, v25, -v24
v_fma_f32 v19, v49, v18, -v17
v_fma_f32 v27, v49, v26, -v25
v_fma_f32 v20, v49, v19, -v18
v_fma_f32 v28, v49, v27, -v26
v_fma_f32 v21, v49, v20, -v19
v_fma_f32 v29, v49, v28, -v27
v_fma_f32 v22, v49, v21, -v20
v_fma_f32 v30, v49, v29, -v28
v_fma_f32 v23, v49, v22, -v21
v_fma_f32 v31, v49, v30, -v29
v_cvt_pk_bf16_f32 v32, v16, v17
v_cvt_pk_bf16_f32 v33, v18, v19
v_cvt_pk_bf16_f32 v34, v20, v21
v_cvt_pk_bf16_f32 v35, v22, v23
ds_write_b128 v13, v[32:35] offset:0
v_cvt_pk_bf16_f32 v36, v24, v25
v_cvt_pk_bf16_f32 v37, v26, v27
v_cvt_pk_bf16_f32 v38, v28, v29
v_cvt_pk_bf16_f32 v39, v30, v31
ds_write_b128 v13, v[36:39] offset:20480
s_cmp_lg_u32 s52, 0
s_cbranch_scc1 k1_fg0
v_add_f32 v50, v50, v50
v_fma_f32 v16, v50, v24, -v16
v_fma_f32 v17, v50, v25, -v17
v_fma_f32 v18, v50, v26, -v18
v_fma_f32 v19, v50, v27, -v19
v_fma_f32 v20, v50, v28, -v20
v_fma_f32 v21, v50, v29, -v21
v_fma_f32 v22, v50, v30, -v22
v_fma_f32 v23, v50, v31, -v23
v_cvt_pk_bf16_f32 v40, v16, v17
v_cvt_pk_bf16_f32 v41, v18, v19
v_cvt_pk_bf16_f32 v42, v20, v21
v_cvt_pk_bf16_f32 v43, v22, v23
ds_write_b128 v13, v[40:43] offset:40960
s_nop 0
k1_fg0:
s_add_u32 s38, s41, 1
s_lshr_b32 s39, s38, 1
s_lshl_b32 s39, s39, 4
s_add_u32 s39, s39, s42
s_and_b32 s38, s38, 1
s_mul_i32 s38, s38, 0x3e800000
v_add_u32 v44, s39, v3
v_mov_b32 v48, s38
v_cndmask_b32 v44, v44, v15, s[50:51]
v_cndmask_b32 v48, v48, 0, s[50:51]
v_mul_u32_u24 v45, v44, v9
v_cvt_f32_u32 v44, v44
v_cvt_f32_u32 v45, v45
v_mul_f32 v47, 0x3acccccd, v44
v_mul_f32 v46, 0x3acccccd, v45
v_cos_f32 v49, v47
v_rndne_f32 v46, v46
v_fma_f32 v45, v46, s43, v45
v_mul_f32 v46, 0x3dcccccd, v44
v_fmamk_f32 v16, v45, 0x3acccccd, v48
v_rndne_f32 v46, v46
v_add_f32 v17, v47, v16
v_fmamk_f32 v46, v46, 0xc1200000, v44
v_add_f32 v49, v49, v49
v_fmamk_f32 v24, v46, 0x3dcccccd, v16
v_fmamk_f32 v25, v46, 0x3dcccccd, v17
v_mul_f32 v46, 0x3dcccccd, v46
v_cos_f32 v16, v16
v_cos_f32 v17, v17
v_cos_f32 v24, v24
v_cos_f32 v25, v25
v_cos_f32 v50, v46
v_fma_f32 v18, v49, v17, -v16
v_fma_f32 v26, v49, v25, -v24
v_fma_f32 v19, v49, v18, -v17
v_fma_f32 v27, v49, v26, -v25
v_fma_f32 v20, v49, v19, -v18
v_fma_f32 v28, v49, v27, -v26
v_fma_f32 v21, v49, v20, -v19
v_fma_f32 v29, v49, v28, -v27
v_fma_f32 v22, v49, v21, -v20
v_fma_f32 v30, v49, v29, -v28
v_fma_f32 v23, v49, v22, -v21
v_fma_f32 v31, v49, v30, -v29
v_cvt_pk_bf16_f32 v32, v16, v17
v_cvt_pk_bf16_f32 v33, v18, v19
v_cvt_pk_bf16_f32 v34, v20, v21
v_cvt_pk_bf16_f32 v35, v22, v23
ds_write_b128 v13, v[32:35] offset:1024
v_cvt_pk_bf16_f32 v36, v24, v25
v_cvt_pk_bf16_f32 v37, v26, v27
v_cvt_pk_bf16_f32 v38, v28, v29
v_cvt_pk_bf16_f32 v39, v30, v31
ds_write_b128 v13, v[36:39] offset:21504
s_cmp_lg_u32 s52, 0
s_cbranch_scc1 k1_fg1
v_add_f32 v50, v50, v50
v_fma_f32 v16, v50, v24, -v16
v_fma_f32 v17, v50, v25, -v17
v_fma_f32 v18, v50, v26, -v18
v_fma_f32 v19, v50, v27, -v19
v_fma_f32 v20, v50, v28, -v20
v_fma_f32 v21, v50, v29, -v21
v_fma_f32 v22, v50, v30, -v22
v_fma_f32 v23, v50, v31, -v23
v_cvt_pk_bf16_f32 v40, v16, v17
v_cvt_pk_bf16_f32 v41, v18, v19
v_cvt_pk_bf16_f32 v42, v20, v21
v_cvt_pk_bf16_f32 v43, v22, v23
ds_write_b128 v13, v[40:43] offset:41984
s_nop 0
k1_fg1:
s_add_u32 s38, s41, 2
s_lshr_b32 s39, s38, 1
s_lshl_b32 s39, s39, 4
s_add_u32 s39, s39, s42
s_and_b32 s38, s38, 1
s_mul_i32 s38, s38, 0x3e800000
v_add_u32 v44, s39, v3
v_mov_b32 v48, s38
v_mul_u32_u24 v45, v44, v9
v_cvt_f32_u32 v44, v44
v_cvt_f32_u32 v45, v45
v_mul_f32 v47, 0x3acccccd, v44
v_mul_f32 v46, 0x3acccccd, v45
v_cos_f32 v49, v47
v_rndne_f32 v46, v46
v_fma_f32 v45, v46, s43, v45
v_mul_f32 v46, 0x3dcccccd, v44
v_fmamk_f32 v16, v45, 0x3acccccd, v48
v_rndne_f32 v46, v46
v_add_f32 v17, v47, v16
v_fmamk_f32 v46, v46, 0xc1200000, v44
v_add_f32 v49, v49, v49
v_fmamk_f32 v24, v46, 0x3dcccccd, v16
v_fmamk_f32 v25, v46, 0x3dcccccd, v17
v_mul_f32 v46, 0x3dcccccd, v46
v_cos_f32 v16, v16
v_cos_f32 v17, v17
v_cos_f32 v24, v24
v_cos_f32 v25, v25
v_cos_f32 v50, v46
v_fma_f32 v18, v49, v17, -v16
v_fma_f32 v26, v49, v25, -v24
v_fma_f32 v19, v49, v18, -v17
v_fma_f32 v27, v49, v26, -v25
v_fma_f32 v20, v49, v19, -v18
v_fma_f32 v28, v49, v27, -v26
v_fma_f32 v21, v49, v20, -v19
v_fma_f32 v29, v49, v28, -v27
v_fma_f32 v22, v49, v21, -v20
v_fma_f32 v30, v49, v29, -v28
v_fma_f32 v23, v49, v22, -v21
v_fma_f32 v31, v49, v30, -v29
v_cvt_pk_bf16_f32 v32, v16, v17
v_cvt_pk_bf16_f32 v33, v18, v19
v_cvt_pk_bf16_f32 v34, v20, v21
v_cvt_pk_bf16_f32 v35, v22, v23
ds_write_b128 v13, v[32:35] offset:2048
v_cvt_pk_bf16_f32 v36, v24, v25
v_cvt_pk_bf16_f32 v37, v26, v27
v_cvt_pk_bf16_f32 v38, v28, v29
v_cvt_pk_bf16_f32 v39, v30, v31
ds_write_b128 v13, v[36:39] offset:22528
s_cmp_lg_u32 s52, 0
s_cbranch_scc1 k1_fg2
v_add_f32 v50, v50, v50
v_fma_f32 v16, v50, v24, -v16
v_fma_f32 v17, v50, v25, -v17
v_fma_f32 v18, v50, v26, -v18
v_fma_f32 v19, v50, v27, -v19
v_fma_f32 v20, v50, v28, -v20
v_fma_f32 v21, v50, v29, -v21
v_fma_f32 v22, v50, v30, -v22
v_fma_f32 v23, v50, v31, -v23
v_cvt_pk_bf16_f32 v40, v16, v17
v_cvt_pk_bf16_f32 v41, v18, v19
v_cvt_pk_bf16_f32 v42, v20, v21
v_cvt_pk_bf16_f32 v43, v22, v23
ds_write_b128 v13, v[40:43] offset:43008
s_nop 0
k1_fg2:
s_add_u32 s38, s41, 3
s_lshr_b32 s39, s38, 1
s_lshl_b32 s39, s39, 4
s_add_u32 s39, s39, s42
s_and_b32 s38, s38, 1
s_mul_i32 s38, s38, 0x3e800000
v_add_u32 v44, s39, v3
v_mov_b32 v48, s38
v_mul_u32_u24 v45, v44, v9
v_cvt_f32_u32 v44, v44
v_cvt_f32_u32 v45, v45
v_mul_f32 v47, 0x3acccccd, v44
v_mul_f32 v46, 0x3acccccd, v45
v_cos_f32 v49, v47
v_rndne_f32 v46, v46
v_fma_f32 v45, v46, s43, v45
v_mul_f32 v46, 0x3dcccccd, v44
v_fmamk_f32 v16, v45, 0x3acccccd, v48
v_rndne_f32 v46, v46
v_add_f32 v17, v47, v16
v_fmamk_f32 v46, v46, 0xc1200000, v44
v_add_f32 v49, v49, v49
v_fmamk_f32 v24, v46, 0x3dcccccd, v16
v_fmamk_f32 v25, v46, 0x3dcccccd, v17
v_mul_f32 v46, 0x3dcccccd, v46
v_cos_f32 v16, v16
v_cos_f32 v17, v17
v_cos_f32 v24, v24
v_cos_f32 v25, v25
v_cos_f32 v50, v46
v_fma_f32 v18, v49, v17, -v16
v_fma_f32 v26, v49, v25, -v24
v_fma_f32 v19, v49, v18, -v17
v_fma_f32 v27, v49, v26, -v25
v_fma_f32 v20, v49, v19, -v18
v_fma_f32 v28, v49, v27, -v26
v_fma_f32 v21, v49, v20, -v19
v_fma_f32 v29, v49, v28, -v27
v_fma_f32 v22, v49, v21, -v20
v_fma_f32 v30, v49, v29, -v28
v_fma_f32 v23, v49, v22, -v21
v_fma_f32 v31, v49, v30, -v29
v_cvt_pk_bf16_f32 v32, v16, v17
v_cvt_pk_bf16_f32 v33, v18, v19
v_cvt_pk_bf16_f32 v34, v20, v21
v_cvt_pk_bf16_f32 v35, v22, v23
ds_write_b128 v13, v[32:35] offset:3072
v_cvt_pk_bf16_f32 v36, v24, v25
v_cvt_pk_bf16_f32 v37, v26, v27
v_cvt_pk_bf16_f32 v38, v28, v29
v_cvt_pk_bf16_f32 v39, v30, v31
ds_write_b128 v13, v[36:39] offset:23552
s_cmp_lg_u32 s52, 0
s_cbranch_scc1 k1_fg3
v_add_f32 v50, v50, v50
v_fma_f32 v16, v50, v24, -v16
v_fma_f32 v17, v50, v25, -v17
v_fma_f32 v18, v50, v26, -v18
v_fma_f32 v19, v50, v27, -v19
v_fma_f32 v20, v50, v28, -v20
v_fma_f32 v21, v50, v29, -v21
v_fma_f32 v22, v50, v30, -v22
v_fma_f32 v23, v50, v31, -v23
v_cvt_pk_bf16_f32 v40, v16, v17
v_cvt_pk_bf16_f32 v41, v18, v19
v_cvt_pk_bf16_f32 v42, v20, v21
v_cvt_pk_bf16_f32 v43, v22, v23
ds_write_b128 v13, v[40:43] offset:44032
s_nop 0
k1_fg3:
s_add_u32 s38, s41, 4
s_lshr_b32 s39, s38, 1
s_lshl_b32 s39, s39, 4
s_add_u32 s39, s39, s42
s_and_b32 s38, s38, 1
s_mul_i32 s38, s38, 0x3e800000
v_add_u32 v44, s39, v3
v_mov_b32 v48, s38
v_mul_u32_u24 v45, v44, v9
v_cvt_f32_u32 v44, v44
v_cvt_f32_u32 v45, v45
v_mul_f32 v47, 0x3acccccd, v44
v_mul_f32 v46, 0x3acccccd, v45
v_cos_f32 v49, v47
v_rndne_f32 v46, v46
v_fma_f32 v45, v46, s43, v45
v_mul_f32 v46, 0x3dcccccd, v44
v_fmamk_f32 v16, v45, 0x3acccccd, v48
v_rndne_f32 v46, v46
v_add_f32 v17, v47, v16
v_fmamk_f32 v46, v46, 0xc1200000, v44
v_add_f32 v49, v49, v49
v_fmamk_f32 v24, v46, 0x3dcccccd, v16
v_fmamk_f32 v25, v46, 0x3dcccccd, v17
v_mul_f32 v46, 0x3dcccccd, v46
v_cos_f32 v16, v16
v_cos_f32 v17, v17
v_cos_f32 v24, v24
v_cos_f32 v25, v25
v_cos_f32 v50, v46
v_fma_f32 v18, v49, v17, -v16
v_fma_f32 v26, v49, v25, -v24
v_fma_f32 v19, v49, v18, -v17
v_fma_f32 v27, v49, v26, -v25
v_fma_f32 v20, v49, v19, -v18
v_fma_f32 v28, v49, v27, -v26
v_fma_f32 v21, v49, v20, -v19
v_fma_f32 v29, v49, v28, -v27
v_fma_f32 v22, v49, v21, -v20
v_fma_f32 v30, v49, v29, -v28
v_fma_f32 v23, v49, v22, -v21
v_fma_f32 v31, v49, v30, -v29
v_cvt_pk_bf16_f32 v32, v16, v17
v_cvt_pk_bf16_f32 v33, v18, v19
v_cvt_pk_bf16_f32 v34, v20, v21
v_cvt_pk_bf16_f32 v35, v22, v23
ds_write_b128 v13, v[32:35] offset:4096
v_cvt_pk_bf16_f32 v36, v24, v25
v_cvt_pk_bf16_f32 v37, v26, v27
v_cvt_pk_bf16_f32 v38, v28, v29
v_cvt_pk_bf16_f32 v39, v30, v31
ds_write_b128 v13, v[36:39] offset:24576
s_cmp_lg_u32 s52, 0
s_cbranch_scc1 k1_fg4
v_add_f32 v50, v50, v50
v_fma_f32 v16, v50, v24, -v16
v_fma_f32 v17, v50, v25, -v17
v_fma_f32 v18, v50, v26, -v18
v_fma_f32 v19, v50, v27, -v19
v_fma_f32 v20, v50, v28, -v20
v_fma_f32 v21, v50, v29, -v21
v_fma_f32 v22, v50, v30, -v22
v_fma_f32 v23, v50, v31, -v23
v_cvt_pk_bf16_f32 v40, v16, v17
v_cvt_pk_bf16_f32 v41, v18, v19
v_cvt_pk_bf16_f32 v42, v20, v21
v_cvt_pk_bf16_f32 v43, v22, v23
ds_write_b128 v13, v[40:43] offset:45056
s_nop 0
k1_fg4:
s_cmp_lg_u32 s52, 0
s_cbranch_scc1 k1_f2
s_lshl_b32 s38, s22, 6
s_add_u32 s38, s38, 0
v_add_u32 v8, s38, v1
v_mul_u32_u24 v9, 3277, v8
v_lshrrev_b32 v9, 16, v9
v_mul_u32_u24 v16, 960, v9
v_lshl_add_u32 v16, v8, 4, v16
s_lshl_b32 s38, s22, 6
s_add_u32 s38, s38, 256
v_add_u32 v8, s38, v1
v_mul_u32_u24 v9, 3277, v8
v_lshrrev_b32 v9, 16, v9
v_mul_u32_u24 v17, 960, v9
v_lshl_add_u32 v17, v8, 4, v17
s_lshl_b32 s38, s22, 6
s_add_u32 s38, s38, 512
v_add_u32 v8, s38, v1
v_mul_u32_u24 v9, 3277, v8
v_lshrrev_b32 v9, 16, v9
v_mul_u32_u24 v18, 960, v9
v_lshl_add_u32 v18, v8, 4, v18
s_lshl_b32 s38, s22, 6
s_add_u32 s38, s38, 768
v_add_u32 v8, s38, v1
v_mul_u32_u24 v9, 3277, v8
v_lshrrev_b32 v9, 16, v9
v_mul_u32_u24 v19, 960, v9
v_lshl_add_u32 v19, v8, 4, v19
s_lshl_b32 s38, s32, 1
s_lshr_b32 s39, s34, 2
s_add_u32 s38, s38, s39
s_mul_i32 s38, s38, 51200
s_and_b32 s39, s34, 3
s_mul_i32 s39, s39, 320
s_add_u32 s39, s38, s39
s_lshl_b32 s38, s22, 10
s_mov_b32 s44, 8
k1_pfloop:
s_waitcnt vmcnt(4) lgkmcnt(0)
s_barrier
s_add_u32 m0, s61, 0
s_nop 0
buffer_load_dwordx4 v4, s[8:11], s46 offen lds
s_add_u32 m0, s61, 1024
s_nop 0
buffer_load_dwordx4 v5, s[8:11], s46 offen lds
s_add_u32 m0, s61, 2048
s_nop 0
buffer_load_dwordx4 v6, s[8:11], s46 offen lds
s_add_u32 m0, s61, 3072
s_nop 0
buffer_load_dwordx4 v7, s[8:11], s46 offen lds
s_add_u32 s46, s46, 128
s_cmp_eq_u32 s46, 1280
s_cselect_b32 s46, 0, s46
s_add_u32 s61, s61, 16384
s_cmp_eq_u32 s61, s62
s_cselect_b32 s61, s48, s61
s_sub_u32 s44, s44, 1
s_cmp_lg_u32 s44, 0
s_cbranch_scc1 k1_pfloop
s_mov_b32 s12, s30
s_mov_b32 s13, s31
s_mov_b32 s14, 819200
s_mov_b32 s15, 0x00020000
s_add_u32 m0, s38, 0
s_nop 0
buffer_load_dwordx4 v16, s[12:15], s39 offen lds
s_add_u32 m0, s38, 4096
s_nop 0
buffer_load_dwordx4 v17, s[12:15], s39 offen lds
s_add_u32 m0, s38, 8192
s_nop 0
buffer_load_dwordx4 v18, s[12:15], s39 offen lds
s_add_u32 m0, s38, 12288
s_nop 0
buffer_load_dwordx4 v19, s[12:15], s39 offen lds
s_waitcnt vmcnt(8)
s_barrier
s_waitcnt vmcnt(4)
s_barrier
s_waitcnt vmcnt(0)
s_add_u32 s27, s34, 16
s_cmp_le_u32 s27, 20
s_barrier
s_cbranch_scc1 k1_mid
s_barrier
s_barrier
s_endpgm
k1_cons:
s_setprio 2
v_mov_b32 v12, 151552
v_mov_b32 v16, 0
v_mov_b32 v17, 0
v_mov_b32 v18, 0
v_mov_b32 v19, 0
ds_write_b128 v12, v[16:19]
ds_write_b128 v12, v[16:19] offset:16
s_lshl_b32 s38, s2, 2
s_add_u32 s38, s38, s22
s_cmp_lg_u32 s38, 1
s_cbranch_scc1 k1_ntok
s_mov_b32 s38, 12460032
s_waitcnt lgkmcnt(0)
buffer_load_dword v16, off, s[16:19], s38 sc1
s_waitcnt vmcnt(0)
v_add_u32 v16, 2654435769, v16
v_not_b32 v17, v16
s_mov_b64 exec, 1
buffer_store_dwordx2 v[16:17], off, s[64:67], 0 sc1
buffer_store_dword v16, off, s[16:19], s38 sc1
s_mov_b64 exec, -1
s_nop 0
k1_ntok:
v_lshrrev_b32 v12, 1, v3
v_xor_b32 v12, v12, v2
v_lshlrev_b32 v12, 4, v12
v_lshl_add_u32 v12, v3, 7, v12
v_add_u32 v6, s48, v12
s_mov_b32 s49, 73728
s_mov_b32 s44, 5
s_cmp_eq_u32 s35, 3
s_cbranch_scc1 k1_f
v_xor_b32 v7, 64, v6
v_lshrrev_b32 v12, 2, v1
v_and_b32 v12, 3, v12
v_lshl_add_u32 v12, v2, 3, v12
v_lshlrev_b32 v12, 6, v12
v_and_b32 v14, 3, v1
v_and_b32 v13, 1, v2
v_lshlrev_b32 v13, 5, v13
s_mov_b32 s40, 0x3fb8aa3b
s_mov_b32 s41, 0x3fb8aa3b
s_mov_b32 s42, 0x358637bd
s_mov_b32 s43, 0x358637bd
s_cmp_eq_u32 s35, 0
s_cselect_b32 s38, 1.0, 0
v_mov_b32 v16, 1.0
v_mov_b32 v17, 1.0
v_mov_b32 v18, 1.0
v_mov_b32 v19, 1.0
v_mov_b32 v20, 1.0
v_mov_b32 v21, 1.0
v_mov_b32 v22, 1.0
v_mov_b32 v23, 1.0
v_mov_b32 v24, 1.0
v_mov_b32 v25, 1.0
v_mov_b32 v26, 1.0
v_mov_b32 v27, 1.0
v_mov_b32 v28, 1.0
v_mov_b32 v29, 1.0
v_mov_b32 v30, 1.0
v_mov_b32 v31, 1.0
v_mov_b32 v32, 1.0
v_mov_b32 v33, 1.0
v_mov_b32 v34, 1.0
v_mov_b32 v35, 1.0
v_mov_b32 v36, 1.0
v_mov_b32 v37, 1.0
v_mov_b32 v38, 1.0
v_mov_b32 v39, 1.0
v_mov_b32 v40, 1.0
v_mov_b32 v41, 1.0
v_mov_b32 v42, 1.0
v_mov_b32 v43, 1.0
v_mov_b32 v44, 1.0
v_mov_b32 v45, 1.0
v_mov_b32 v46, 1.0
v_mov_b32 v47, 1.0
v_mov_b32 v48, 1.0
v_mov_b32 v49, 1.0
v_mov_b32 v50, 1.0
v_mov_b32 v51, 1.0
v_mov_b32 v52, 1.0
v_mov_b32 v53, 1.0
v_mov_b32 v54, 1.0
v_mov_b32 v55, 1.0
v_mov_b32 v56, s38
v_mov_b32 v57, s38
v_mov_b32 v58, s38
v_mov_b32 v59, s38
v_mov_b32 v60, s38
v_mov_b32 v61, s38
v_mov_b32 v62, s38
v_mov_b32 v63, s38
v_mov_b32 v64, s38
v_mov_b32 v65, s38
v_mov_b32 v66, s38
v_mov_b32 v67, s38
v_mov_b32 v68, s38
v_mov_b32 v69, s38
v_mov_b32 v70, s38
v_mov_b32 v71, s38
v_mov_b32 v72, s38
v_mov_b32 v73, s38
v_mov_b32 v74, s38
v_mov_b32 v75, s38
v_mov_b32 v76, s38
v_mov_b32 v77, s38
v_mov_b32 v78, s38
v_mov_b32 v79, s38
v_mov_b32 v80, s38
v_mov_b32 v81, s38
v_mov_b32 v82, s38
v_mov_b32 v83, s38
v_mov_b32 v84, s38
v_mov_b32 v85, s38
v_mov_b32 v86, s38
v_mov_b32 v87, s38
v_mov_b32 v88, s38
v_mov_b32 v89, s38
v_mov_b32 v90, s38
v_mov_b32 v91, s38
v_mov_b32 v92, s38
v_mov_b32 v93, s38
v_mov_b32 v94, s38
v_mov_b32 v95, s38
s_nop 1
s_cbranch_scc1 k1_q
v_lshl_add_u32 v12, v14, 3, v12
v_add_u32 v4, v12, v13
v_xor_b32 v13, 32, v13
v_add_u32 v5, v12, v13
s_waitcnt lgkmcnt(0)
s_barrier
ds_read_b128 v[160:163], v6 offset:0
ds_read_b64_tr_b16 v[176:177], v4 offset:0
ds_read_b64_tr_b16 v[178:179], v4 offset:256
ds_read_b128 v[164:167], v6 offset:2048
ds_read_b64_tr_b16 v[180:181], v5 offset:0
ds_read_b64_tr_b16 v[182:183], v5 offset:256
ds_read_b64_tr_b16 v[184:185], v4 offset:4096
ds_read_b64_tr_b16 v[186:187], v4 offset:4352
ds_read_b64_tr_b16 v[188:189], v5 offset:4096
ds_read_b64_tr_b16 v[190:191], v5 offset:4352
ds_read_b64_tr_b16 v[192:193], v4 offset:8192
ds_read_b64_tr_b16 v[194:195], v4 offset:8448
ds_read_b64_tr_b16 v[196:197], v5 offset:8192
ds_read_b64_tr_b16 v[198:199], v5 offset:8448
ds_read_b64_tr_b16 v[200:201], v4 offset:12288
ds_read_b64_tr_b16 v[202:203], v4 offset:12544
ds_read_b64_tr_b16 v[204:205], v5 offset:12288
ds_read_b64_tr_b16 v[206:207], v5 offset:12544
ds_read_b64_tr_b16 v[208:209], v4 offset:16384
ds_read_b64_tr_b16 v[210:211], v4 offset:16640
ds_read_b64_tr_b16 v[212:213], v5 offset:16384
ds_read_b64_tr_b16 v[214:215], v5 offset:16640
k1_kvloop:
s_waitcnt lgkmcnt(10)
v_mfma_f32_16x16x32_bf16 v[16:19], v[160:163], v[176:179], v[16:19]
ds_read_b128 v[168:171], v7 offset:0
ds_read_b64_tr_b16 v[216:217], v4 offset:2048
v_mfma_f32_16x16x32_bf16 v[20:23], v[164:167], v[176:179], v[20:23]
ds_read_b64_tr_b16 v[218:219], v4 offset:2304
ds_read_b128 v[172:175], v7 offset:2048
v_mfma_f32_16x16x32_bf16 v[24:27], v[160:163], v[180:183], v[24:27]
ds_read_b64_tr_b16 v[220:221], v5 offset:2048
v_mfma_f32_16x16x32_bf16 v[28:31], v[164:167], v[180:183], v[28:31]
ds_read_b64_tr_b16 v[222:223], v5 offset:2304
v_mfma_f32_16x16x32_bf16 v[32:35], v[160:163], v[184:187], v[32:35]
ds_read_b64_tr_b16 v[224:225], v4 offset:6144
v_mfma_f32_16x16x32_bf16 v[36:39], v[164:167], v[184:187], v[36:39]
ds_read_b64_tr_b16 v[226:227], v4 offset:6400
v_mfma_f32_16x16x32_bf16 v[40:43], v[160:163], v[188:191], v[40:43]
ds_read_b64_tr_b16 v[228:229], v5 offset:6144
v_mfma_f32_16x16x32_bf16 v[44:47], v[164:167], v[188:191], v[44:47]
ds_read_b64_tr_b16 v[230:231], v5 offset:6400
v_mfma_f32_16x16x32_bf16 v[48:51], v[160:163], v[192:195], v[48:51]
ds_read_b64_tr_b16 v[232:233], v4 offset:10240
v_mfma_f32_16x16x32_bf16 v[52:55], v[164:167], v[192:195], v[52:55]
ds_read_b64_tr_b16 v[234:235], v4 offset:10496
s_waitcnt lgkmcnt(12)
v_mfma_f32_16x16x32_bf16 v[56:59], v[160:163], v[196:199], v[56:59]
ds_read_b64_tr_b16 v[236:237], v5 offset:10240
v_mfma_f32_16x16x32_bf16 v[60:63], v[164:167], v[196:199], v[60:63]
ds_read_b64_tr_b16 v[238:239], v5 offset:10496
v_mfma_f32_16x16x32_bf16 v[64:67], v[160:163], v[200:203], v[64:67]
ds_read_b64_tr_b16 v[240:241], v4 offset:14336
v_mfma_f32_16x16x32_bf16 v[68:71], v[164:167], v[200:203], v[68:71]
ds_read_b64_tr_b16 v[242:243], v4 offset:14592
v_mfma_f32_16x16x32_bf16 v[72:75], v[160:163], v[204:207], v[72:75]
ds_read_b64_tr_b16 v[244:245], v5 offset:14336
v_mfma_f32_16x16x32_bf16 v[76:79], v[164:167], v[204:207], v[76:79]
ds_read_b64_tr_b16 v[246:247], v5 offset:14592
v_mfma_f32_16x16x32_bf16 v[80:83], v[160:163], v[208:211], v[80:83]
ds_read_b64_tr_b16 v[248:249], v4 offset:18432
v_mfma_f32_16x16x32_bf16 v[84:87], v[164:167], v[208:211], v[84:87]
ds_read_b64_tr_b16 v[250:251], v4 offset:18688
v_mfma_f32_16x16x32_bf16 v[88:91], v[160:163], v[212:215], v[88:91]
ds_read_b64_tr_b16 v[252:253], v5 offset:18432
v_mfma_f32_16x16x32_bf16 v[92:95], v[164:167], v[212:215], v[92:95]
ds_read_b64_tr_b16 v[254:255], v5 offset:18688
s_waitcnt lgkmcnt(10)
v_mfma_f32_16x16x32_bf16 v[16:19], v[168:171], v[216:219], v[16:19]
v_mfma_f32_16x16x32_bf16 v[20:23], v[172:175], v[216:219], v[20:23]
v_mfma_f32_16x16x32_bf16 v[24:27], v[168:171], v[220:223], v[24:27]
v_mfma_f32_16x16x32_bf16 v[28:31], v[172:175], v[220:223], v[28:31]
s_waitcnt lgkmcnt(0)
s_barrier
v_mfma_f32_16x16x32_bf16 v[32:35], v[168:171], v[224:227], v[32:35]
ds_read_b128 v[160:163], v6 offset:36864
ds_read_b64_tr_b16 v[176:177], v4 offset:36864
v_mfma_f32_16x16x32_bf16 v[36:39], v[172:175], v[224:227], v[36:39]
ds_read_b64_tr_b16 v[178:179], v4 offset:37120
ds_read_b128 v[164:167], v6 offset:38912
v_mfma_f32_16x16x32_bf16 v[40:43], v[168:171], v[228:231], v[40:43]
ds_read_b64_tr_b16 v[180:181], v5 offset:36864
ds_read_b64_tr_b16 v[182:183], v5 offset:37120
v_mfma_f32_16x16x32_bf16 v[44:47], v[172:175], v[228:231], v[44:47]
ds_read_b64_tr_b16 v[184:185], v4 offset:40960
ds_read_b64_tr_b16 v[186:187], v4 offset:41216
v_mfma_f32_16x16x32_bf16 v[48:51], v[168:171], v[232:235], v[48:51]
ds_read_b64_tr_b16 v[188:189], v5 offset:40960
ds_read_b64_tr_b16 v[190:191], v5 offset:41216
v_mfma_f32_16x16x32_bf16 v[52:55], v[172:175], v[232:235], v[52:55]
ds_read_b64_tr_b16 v[192:193], v4 offset:45056
ds_read_b64_tr_b16 v[194:195], v4 offset:45312
v_mfma_f32_16x16x32_bf16 v[56:59], v[168:171], v[236:239], v[56:59]
ds_read_b64_tr_b16 v[196:197], v5 offset:45056
ds_read_b64_tr_b16 v[198:199], v5 offset:45312
v_mfma_f32_16x16x32_bf16 v[60:63], v[172:175], v[236:239], v[60:63]
ds_read_b64_tr_b16 v[200:201], v4 offset:49152
ds_read_b64_tr_b16 v[202:203], v4 offset:49408
v_mfma_f32_16x16x32_bf16 v[64:67], v[168:171], v[240:243], v[64:67]
ds_read_b64_tr_b16 v[204:205], v5 offset:49152
ds_read_b64_tr_b16 v[206:207], v5 offset:49408
v_mfma_f32_16x16x32_bf16 v[68:71], v[172:175], v[240:243], v[68:71]
ds_read_b64_tr_b16 v[208:209], v4 offset:53248
ds_read_b64_tr_b16 v[210:211], v4 offset:53504
v_mfma_f32_16x16x32_bf16 v[72:75], v[168:171], v[244:247], v[72:75]
ds_read_b64_tr_b16 v[212:213], v5 offset:53248
ds_read_b64_tr_b16 v[214:215], v5 offset:53504
v_mfma_f32_16x16x32_bf16 v[76:79], v[172:175], v[244:247], v[76:79]
v_mfma_f32_16x16x32_bf16 v[80:83], v[168:171], v[248:251], v[80:83]
v_mfma_f32_16x16x32_bf16 v[84:87], v[172:175], v[248:251], v[84:87]
v_mfma_f32_16x16x32_bf16 v[88:91], v[168:171], v[252:255], v[88:91]
v_mfma_f32_16x16x32_bf16 v[92:95], v[172:175], v[252:255], v[92:95]
s_waitcnt lgkmcnt(10)
v_mfma_f32_16x16x32_bf16 v[16:19], v[160:163], v[176:179], v[16:19]
ds_read_b128 v[168:171], v7 offset:36864
ds_read_b64_tr_b16 v[216:217], v4 offset:38912
v_mfma_f32_16x16x32_bf16 v[20:23], v[164:167], v[176:179], v[20:23]
ds_read_b64_tr_b16 v[218:219], v4 offset:39168
ds_read_b128 v[172:175], v7 offset:38912
v_mfma_f32_16x16x32_bf16 v[24:27], v[160:163], v[180:183], v[24:27]
ds_read_b64_tr_b16 v[220:221], v5 offset:38912
v_mfma_f32_16x16x32_bf16 v[28:31], v[164:167], v[180:183], v[28:31]
ds_read_b64_tr_b16 v[222:223], v5 offset:39168
v_mfma_f32_16x16x32_bf16 v[32:35], v[160:163], v[184:187], v[32:35]
ds_read_b64_tr_b16 v[224:225], v4 offset:43008
v_mfma_f32_16x16x32_bf16 v[36:39], v[164:167], v[184:187], v[36:39]
ds_read_b64_tr_b16 v[226:227], v4 offset:43264
v_mfma_f32_16x16x32_bf16 v[40:43], v[160:163], v[188:191], v[40:43]
ds_read_b64_tr_b16 v[228:229], v5 offset:43008
v_mfma_f32_16x16x32_bf16 v[44:47], v[164:167], v[188:191], v[44:47]
ds_read_b64_tr_b16 v[230:231], v5 offset:43264
v_mfma_f32_16x16x32_bf16 v[48:51], v[160:163], v[192:195], v[48:51]
ds_read_b64_tr_b16 v[232:233], v4 offset:47104
v_mfma_f32_16x16x32_bf16 v[52:55], v[164:167], v[192:195], v[52:55]
ds_read_b64_tr_b16 v[234:235], v4 offset:47360
s_waitcnt lgkmcnt(12)
v_mfma_f32_16x16x32_bf16 v[56:59], v[160:163], v[196:199], v[56:59]
ds_read_b64_tr_b16 v[236:237], v5 offset:47104
v_mfma_f32_16x16x32_bf16 v[60:63], v[164:167], v[196:199], v[60:63]
ds_read_b64_tr_b16 v[238:239], v5 offset:47360
v_mfma_f32_16x16x32_bf16 v[64:67], v[160:163], v[200:203], v[64:67]
ds_read_b64_tr_b16 v[240:241], v4 offset:51200
v_mfma_f32_16x16x32_bf16 v[68:71], v[164:167], v[200:203], v[68:71]
ds_read_b64_tr_b16 v[242:243], v4 offset:51456
v_mfma_f32_16x16x32_bf16 v[72:75], v[160:163], v[204:207], v[72:75]
ds_read_b64_tr_b16 v[244:245], v5 offset:51200
v_mfma_f32_16x16x32_bf16 v[76:79], v[164:167], v[204:207], v[76:79]
ds_read_b64_tr_b16 v[246:247], v5 offset:51456
v_mfma_f32_16x16x32_bf16 v[80:83], v[160:163], v[208:211], v[80:83]
ds_read_b64_tr_b16 v[248:249], v4 offset:55296
v_mfma_f32_16x16x32_bf16 v[84:87], v[164:167], v[208:211], v[84:87]
ds_read_b64_tr_b16 v[250:251], v4 offset:55552
v_mfma_f32_16x16x32_bf16 v[88:91], v[160:163], v[212:215], v[88:91]
ds_read_b64_tr_b16 v[252:253], v5 offset:55296
v_mfma_f32_16x16x32_bf16 v[92:95], v[164:167], v[212:215], v[92:95]
ds_read_b64_tr_b16 v[254:255], v5 offset:55552
s_waitcnt lgkmcnt(10)
v_mfma_f32_16x16x32_bf16 v[16:19], v[168:171], v[216:219], v[16:19]
v_add_u32 v6, s49, v6
v_add_u32 v7, s49, v7
v_mfma_f32_16x16x32_bf16 v[20:23], v[172:175], v[216:219], v[20:23]
v_add_u32 v4, s49, v4
v_add_u32 v5, s49, v5
v_mfma_f32_16x16x32_bf16 v[24:27], v[168:171], v[220:223], v[24:27]
s_sub_u32 s49, 0, s49
s_sub_u32 s44, s44, 1
v_mfma_f32_16x16x32_bf16 v[28:31], v[172:175], v[220:223], v[28:31]
s_cmp_lg_u32 s44, 0
s_waitcnt lgkmcnt(0)
s_barrier
v_mfma_f32_16x16x32_bf16 v[32:35], v[168:171], v[224:227], v[32:35]
ds_read_b128 v[160:163], v6 offset:0
ds_read_b64_tr_b16 v[176:177], v4 offset:0
v_mfma_f32_16x16x32_bf16 v[36:39], v[172:175], v[224:227], v[36:39]
ds_read_b64_tr_b16 v[178:179], v4 offset:256
ds_read_b128 v[164:167], v6 offset:2048
v_mfma_f32_16x16x32_bf16 v[40:43], v[168:171], v[228:231], v[40:43]
ds_read_b64_tr_b16 v[180:181], v5 offset:0
ds_read_b64_tr_b16 v[182:183], v5 offset:256
v_mfma_f32_16x16x32_bf16 v[44:47], v[172:175], v[228:231], v[44:47]
ds_read_b64_tr_b16 v[184:185], v4 offset:4096
ds_read_b64_tr_b16 v[186:187], v4 offset:4352
v_mfma_f32_16x16x32_bf16 v[48:51], v[168:171], v[232:235], v[48:51]
ds_read_b64_tr_b16 v[188:189], v5 offset:4096
ds_read_b64_tr_b16 v[190:191], v5 offset:4352
v_mfma_f32_16x16x32_bf16 v[52:55], v[172:175], v[232:235], v[52:55]
ds_read_b64_tr_b16 v[192:193], v4 offset:8192
ds_read_b64_tr_b16 v[194:195], v4 offset:8448
v_mfma_f32_16x16x32_bf16 v[56:59], v[168:171], v[236:239], v[56:59]
ds_read_b64_tr_b16 v[196:197], v5 offset:8192
ds_read_b64_tr_b16 v[198:199], v5 offset:8448
v_mfma_f32_16x16x32_bf16 v[60:63], v[172:175], v[236:239], v[60:63]
ds_read_b64_tr_b16 v[200:201], v4 offset:12288
ds_read_b64_tr_b16 v[202:203], v4 offset:12544
v_mfma_f32_16x16x32_bf16 v[64:67], v[168:171], v[240:243], v[64:67]
ds_read_b64_tr_b16 v[204:205], v5 offset:12288
ds_read_b64_tr_b16 v[206:207], v5 offset:12544
v_mfma_f32_16x16x32_bf16 v[68:71], v[172:175], v[240:243], v[68:71]
ds_read_b64_tr_b16 v[208:209], v4 offset:16384
ds_read_b64_tr_b16 v[210:211], v4 offset:16640
v_mfma_f32_16x16x32_bf16 v[72:75], v[168:171], v[244:247], v[72:75]
ds_read_b64_tr_b16 v[212:213], v5 offset:16384
ds_read_b64_tr_b16 v[214:215], v5 offset:16640
v_mfma_f32_16x16x32_bf16 v[76:79], v[172:175], v[244:247], v[76:79]
v_mfma_f32_16x16x32_bf16 v[80:83], v[168:171], v[248:251], v[80:83]
v_mfma_f32_16x16x32_bf16 v[84:87], v[172:175], v[248:251], v[84:87]
v_mfma_f32_16x16x32_bf16 v[88:91], v[168:171], v[252:255], v[88:91]
v_mfma_f32_16x16x32_bf16 v[92:95], v[172:175], v[252:255], v[92:95]
s_cbranch_scc1 k1_kvloop
buffer_load_dwordx2 v[148:149], off, s[64:67], 0 sc1
s_mul_i32 s38, s22, 10240
v_add_u32 v13, s38, v11
v_cvt_pk_bf16_f32 v116, v56, v57
v_cvt_pk_bf16_f32 v117, v58, v59
v_cvt_pk_bf16_f32 v118, v60, v61
v_cvt_pk_bf16_f32 v119, v62, v63
ds_write_b128 v13, v[116:119] offset:5120
v_cvt_pk_bf16_f32 v120, v64, v65
v_cvt_pk_bf16_f32 v121, v66, v67
v_cvt_pk_bf16_f32 v122, v68, v69
v_cvt_pk_bf16_f32 v123, v70, v71
ds_write_b128 v13, v[120:123] offset:6144
v_cvt_pk_bf16_f32 v124, v72, v73
v_cvt_pk_bf16_f32 v125, v74, v75
v_cvt_pk_bf16_f32 v126, v76, v77
v_cvt_pk_bf16_f32 v127, v78, v79
ds_write_b128 v13, v[124:127] offset:7168
v_cvt_pk_bf16_f32 v128, v80, v81
v_cvt_pk_bf16_f32 v129, v82, v83
v_cvt_pk_bf16_f32 v130, v84, v85
v_cvt_pk_bf16_f32 v131, v86, v87
ds_write_b128 v13, v[128:131] offset:8192
v_cvt_pk_bf16_f32 v132, v88, v89
v_cvt_pk_bf16_f32 v133, v90, v91
v_cvt_pk_bf16_f32 v134, v92, v93
v_cvt_pk_bf16_f32 v135, v94, v95
ds_write_b128 v13, v[132:135] offset:9216
v_pk_fma_f32 v[136:137], v[16:17], s[40:41], s[40:41] neg_lo:[0,0,1] neg_hi:[0,0,1]
v_pk_fma_f32 v[138:139], v[18:19], s[40:41], s[40:41] neg_lo:[0,0,1] neg_hi:[0,0,1]
v_pk_fma_f32 v[140:141], v[20:21], s[40:41], s[40:41] neg_lo:[0,0,1] neg_hi:[0,0,1]
v_pk_fma_f32 v[142:143], v[22:23], s[40:41], s[40:41] neg_lo:[0,0,1] neg_hi:[0,0,1]
v_exp_f32_e64 v136, v136 clamp
v_exp_f32_e64 v137, v137 clamp
v_exp_f32_e64 v138, v138 clamp
v_exp_f32_e64 v139, v139 clamp
v_exp_f32_e64 v140, v140 clamp
v_exp_f32_e64 v141, v141 clamp
v_exp_f32_e64 v142, v142 clamp
v_exp_f32_e64 v143, v143 clamp
v_max_f32 v16, v16, v136
v_max_f32 v17, v17, v137
v_max_f32 v18, v18, v138
v_max_f32 v19, v19, v139
v_max_f32 v20, v20, v140
v_max_f32 v21, v21, v141
v_max_f32 v22, v22, v142
v_max_f32 v23, v23, v143
v_pk_add_f32 v[16:17], v[16:17], s[42:43]
v_pk_add_f32 v[18:19], v[18:19], s[42:43]
v_pk_add_f32 v[20:21], v[20:21], s[42:43]
v_pk_add_f32 v[22:23], v[22:23], s[42:43]
v_cvt_pk_bf16_f32 v96, v16, v17
v_cvt_pk_bf16_f32 v97, v18, v19
v_cvt_pk_bf16_f32 v98, v20, v21
v_cvt_pk_bf16_f32 v99, v22, v23
ds_write_b128 v13, v[96:99] offset:0
v_pk_fma_f32 v[136:137], v[24:25], s[40:41], s[40:41] neg_lo:[0,0,1] neg_hi:[0,0,1]
v_pk_fma_f32 v[138:139], v[26:27], s[40:41], s[40:41] neg_lo:[0,0,1] neg_hi:[0,0,1]
v_pk_fma_f32 v[140:141], v[28:29], s[40:41], s[40:41] neg_lo:[0,0,1] neg_hi:[0,0,1]
v_pk_fma_f32 v[142:143], v[30:31], s[40:41], s[40:41] neg_lo:[0,0,1] neg_hi:[0,0,1]
v_exp_f32_e64 v136, v136 clamp
v_exp_f32_e64 v137, v137 clamp
v_exp_f32_e64 v138, v138 clamp
v_exp_f32_e64 v139, v139 clamp
v_exp_f32_e64 v140, v140 clamp
v_exp_f32_e64 v141, v141 clamp
v_exp_f32_e64 v142, v142 clamp
v_exp_f32_e64 v143, v143 clamp
v_max_f32 v24, v24, v136
v_max_f32 v25, v25, v137
v_max_f32 v26, v26, v138
v_max_f32 v27, v27, v139
v_max_f32 v28, v28, v140
v_max_f32 v29, v29, v141
v_max_f32 v30, v30, v142
v_max_f32 v31, v31, v143
v_pk_add_f32 v[24:25], v[24:25], s[42:43]
v_pk_add_f32 v[26:27], v[26:27], s[42:43]
v_pk_add_f32 v[28:29], v[28:29], s[42:43]
v_pk_add_f32 v[30:31], v[30:31], s[42:43]
v_cvt_pk_bf16_f32 v100, v24, v25
v_cvt_pk_bf16_f32 v101, v26, v27
v_cvt_pk_bf16_f32 v102, v28, v29
v_cvt_pk_bf16_f32 v103, v30, v31
ds_write_b128 v13, v[100:103] offset:1024
v_pk_fma_f32 v[136:137], v[32:33], s[40:41], s[40:41] neg_lo:[0,0,1] neg_hi:[0,0,1]
v_pk_fma_f32 v[138:139], v[34:35], s[40:41], s[40:41] neg_lo:[0,0,1] neg_hi:[0,0,1]
v_pk_fma_f32 v[140:141], v[36:37], s[40:41], s[40:41] neg_lo:[0,0,1] neg_hi:[0,0,1]
v_pk_fma_f32 v[142:143], v[38:39], s[40:41], s[40:41] neg_lo:[0,0,1] neg_hi:[0,0,1]
v_exp_f32_e64 v136, v136 clamp
v_exp_f32_e64 v137, v137 clamp
v_exp_f32_e64 v138, v138 clamp
v_exp_f32_e64 v139, v139 clamp
v_exp_f32_e64 v140, v140 clamp
v_exp_f32_e64 v141, v141 clamp
v_exp_f32_e64 v142, v142 clamp
v_exp_f32_e64 v143, v143 clamp
v_max_f32 v32, v32, v136
v_max_f32 v33, v33, v137
v_max_f32 v34, v34, v138
v_max_f32 v35, v35, v139
v_max_f32 v36, v36, v140
v_max_f32 v37, v37, v141
v_max_f32 v38, v38, v142
v_max_f32 v39, v39, v143
v_pk_add_f32 v[32:33], v[32:33], s[42:43]
v_pk_add_f32 v[34:35], v[34:35], s[42:43]
v_pk_add_f32 v[36:37], v[36:37], s[42:43]
v_pk_add_f32 v[38:39], v[38:39], s[42:43]
v_cvt_pk_bf16_f32 v104, v32, v33
v_cvt_pk_bf16_f32 v105, v34, v35
v_cvt_pk_bf16_f32 v106, v36, v37
v_cvt_pk_bf16_f32 v107, v38, v39
ds_write_b128 v13, v[104:107] offset:2048
v_pk_fma_f32 v[136:137], v[40:41], s[40:41], s[40:41] neg_lo:[0,0,1] neg_hi:[0,0,1]
v_pk_fma_f32 v[138:139], v[42:43], s[40:41], s[40:41] neg_lo:[0,0,1] neg_hi:[0,0,1]
v_pk_fma_f32 v[140:141], v[44:45], s[40:41], s[40:41] neg_lo:[0,0,1] neg_hi:[0,0,1]
v_pk_fma_f32 v[142:143], v[46:47], s[40:41], s[40:41] neg_lo:[0,0,1] neg_hi:[0,0,1]
v_exp_f32_e64 v136, v136 clamp
v_exp_f32_e64 v137, v137 clamp
v_exp_f32_e64 v138, v138 clamp
v_exp_f32_e64 v139, v139 clamp
v_exp_f32_e64 v140, v140 clamp
v_exp_f32_e64 v141, v141 clamp
v_exp_f32_e64 v142, v142 clamp
v_exp_f32_e64 v143, v143 clamp
v_max_f32 v40, v40, v136
v_max_f32 v41, v41, v137
v_max_f32 v42, v42, v138
v_max_f32 v43, v43, v139
v_max_f32 v44, v44, v140
v_max_f32 v45, v45, v141
v_max_f32 v46, v46, v142
v_max_f32 v47, v47, v143
v_pk_add_f32 v[40:41], v[40:41], s[42:43]
v_pk_add_f32 v[42:43], v[42:43], s[42:43]
v_pk_add_f32 v[44:45], v[44:45], s[42:43]
v_pk_add_f32 v[46:47], v[46:47], s[42:43]
v_cvt_pk_bf16_f32 v108, v40, v41
v_cvt_pk_bf16_f32 v109, v42, v43
v_cvt_pk_bf16_f32 v110, v44, v45
v_cvt_pk_bf16_f32 v111, v46, v47
ds_write_b128 v13, v[108:111] offset:3072
v_pk_fma_f32 v[136:137], v[48:49], s[40:41], s[40:41] neg_lo:[0,0,1] neg_hi:[0,0,1]
v_pk_fma_f32 v[138:139], v[50:51], s[40:41], s[40:41] neg_lo:[0,0,1] neg_hi:[0,0,1]
v_pk_fma_f32 v[140:141], v[52:53], s[40:41], s[40:41] neg_lo:[0,0,1] neg_hi:[0,0,1]
v_pk_fma_f32 v[142:143], v[54:55], s[40:41], s[40:41] neg_lo:[0,0,1] neg_hi:[0,0,1]
v_exp_f32_e64 v136, v136 clamp
v_exp_f32_e64 v137, v137 clamp
v_exp_f32_e64 v138, v138 clamp
v_exp_f32_e64 v139, v139 clamp
v_exp_f32_e64 v140, v140 clamp
v_exp_f32_e64 v141, v141 clamp
v_exp_f32_e64 v142, v142 clamp
v_exp_f32_e64 v143, v143 clamp
v_max_f32 v48, v48, v136
v_max_f32 v49, v49, v137
v_max_f32 v50, v50, v138
v_max_f32 v51, v51, v139
v_max_f32 v52, v52, v140
v_max_f32 v53, v53, v141
v_max_f32 v54, v54, v142
v_max_f32 v55, v55, v143
v_pk_add_f32 v[48:49], v[48:49], s[42:43]
v_pk_add_f32 v[50:51], v[50:51], s[42:43]
v_pk_add_f32 v[52:53], v[52:53], s[42:43]
v_pk_add_f32 v[54:55], v[54:55], s[42:43]
v_cvt_pk_bf16_f32 v112, v48, v49
v_cvt_pk_bf16_f32 v113, v50, v51
v_cvt_pk_bf16_f32 v114, v52, v53
v_cvt_pk_bf16_f32 v115, v54, v55
ds_write_b128 v13, v[112:115] offset:4096
v_lshlrev_b32 v15, 2, v1
s_lshl_b32 s38, s20, 3
s_add_u32 s38, s38, s36
s_mul_i32 s38, s38, 10240
s_add_u32 s38, s38, 8716288
s_mul_i32 s39, s20, 5120
s_mul_i32 s44, s36, 640
s_add_u32 s39, s39, s44
s_add_u32 s39, s39, 10485760
s_lshl_b32 s45, s36, 11
s_lshl_b32 s44, s20, 7
s_add_u32 s45, s45, s44
s_add_u32 s45, s45, 12206080
v_mov_b32 v140, 0x3f803f80
v_mov_b32 v141, 0x3f803f80
v_mov_b32 v142, 0x3f803f80
v_mov_b32 v143, 0x3f803f80
s_waitcnt lgkmcnt(0)
s_barrier
s_cmp_eq_u32 s22, 0
s_cbranch_scc1 k1_kvw0
s_cmp_eq_u32 s22, 1
s_cbranch_scc1 k1_kvw1
s_cmp_eq_u32 s22, 2
s_cbranch_scc1 k1_kvw2
ds_read_b128 v[16:19], v11 offset:7168
ds_read_b128 v[20:23], v11 offset:3072
ds_read_b128 v[24:27], v11 offset:8192
ds_read_b128 v[28:31], v11 offset:9216
ds_read_b128 v[32:35], v11 offset:4096
ds_read_b128 v[40:43], v11 offset:17408
ds_read_b128 v[44:47], v11 offset:13312
ds_read_b128 v[48:51], v11 offset:18432
ds_read_b128 v[52:55], v11 offset:19456
ds_read_b128 v[56:59], v11 offset:14336
ds_read_b128 v[64:67], v11 offset:27648
ds_read_b128 v[68:71], v11 offset:23552
ds_read_b128 v[72:75], v11 offset:28672
ds_read_b128 v[76:79], v11 offset:29696
ds_read_b128 v[80:83], v11 offset:24576
ds_read_b128 v[88:91], v11 offset:37888
ds_read_b128 v[92:95], v11 offset:33792
ds_read_b128 v[96:99], v11 offset:38912
ds_read_b128 v[100:103], v11 offset:39936
ds_read_b128 v[104:107], v11 offset:34816
s_waitcnt lgkmcnt(15)
v_mfma_f32_16x16x32_bf16 v[112:115], v[16:19], v[20:23], 0
v_mfma_f32_16x16x32_bf16 v[116:119], v[24:27], v[20:23], 0
v_mfma_f32_16x16x32_bf16 v[120:123], v[28:31], v[20:23], 0
v_mfma_f32_16x16x32_bf16 v[124:127], v[140:143], v[20:23], 0
v_mfma_f32_16x16x32_bf16 v[128:131], v[140:143], v[32:35], 0
s_waitcnt lgkmcnt(10)
v_mfma_f32_16x16x32_bf16 v[112:115], v[40:43], v[44:47], v[112:115]
v_mfma_f32_16x16x32_bf16 v[116:119], v[48:51], v[44:47], v[116:119]
v_mfma_f32_16x16x32_bf16 v[120:123], v[52:55], v[44:47], v[120:123]
v_mfma_f32_16x16x32_bf16 v[124:127], v[140:143], v[44:47], v[124:127]
v_mfma_f32_16x16x32_bf16 v[128:131], v[140:143], v[56:59], v[128:131]
s_waitcnt lgkmcnt(5)
v_mfma_f32_16x16x32_bf16 v[112:115], v[64:67], v[68:71], v[112:115]
v_mfma_f32_16x16x32_bf16 v[116:119], v[72:75], v[68:71], v[116:119]
v_mfma_f32_16x16x32_bf16 v[120:123], v[76:79], v[68:71], v[120:123]
v_mfma_f32_16x16x32_bf16 v[124:127], v[140:143], v[68:71], v[124:127]
v_mfma_f32_16x16x32_bf16 v[128:131], v[140:143], v[80:83], v[128:131]
s_waitcnt lgkmcnt(0)
v_mfma_f32_16x16x32_bf16 v[112:115], v[88:91], v[92:95], v[112:115]
v_mfma_f32_16x16x32_bf16 v[116:119], v[96:99], v[92:95], v[116:119]
v_mfma_f32_16x16x32_bf16 v[120:123], v[100:103], v[92:95], v[120:123]
v_mfma_f32_16x16x32_bf16 v[124:127], v[140:143], v[92:95], v[124:127]
v_mfma_f32_16x16x32_bf16 v[128:131], v[140:143], v[104:107], v[128:131]
s_nop 3
v_cvt_pk_bf16_f32 v16, v112, v113
v_cvt_pk_bf16_f32 v17, v114, v115
v_cvt_pk_bf16_f32 v18, v116, v117
v_cvt_pk_bf16_f32 v19, v118, v119
s_add_u32 s44, s38, 6144
buffer_store_dwordx4 v[16:19], v11, s[16:19], s44 offen sc1
s_mov_b64 exec, 0xffffffff
buffer_store_dword v124, v15, s[16:19], s39 offen offset:384 sc1
buffer_store_dword v128, v15, s[16:19], s39 offen offset:512 sc1
s_mov_b64 exec, -1
v_cvt_pk_bf16_f32 v20, v120, v121
v_cvt_pk_bf16_f32 v21, v122, v123
s_add_u32 s44, s38, 7168
buffer_store_dwordx4 v[20:23], v11, s[16:19], s44 offen sc1
s_nop 1
s_branch k1_kvend
k1_kvw0:
ds_read_b128 v[16:19], v11 offset:5120
ds_read_b128 v[20:23], v11 offset:0
ds_read_b128 v[24:27], v11 offset:6144
ds_read_b128 v[28:31], v11 offset:8192
ds_read_b128 v[32:35], v11 offset:4096
ds_read_b128 v[36:39], v11 offset:9216
ds_read_b128 v[40:43], v11 offset:15360
ds_read_b128 v[44:47], v11 offset:10240
ds_read_b128 v[48:51], v11 offset:16384
ds_read_b128 v[52:55], v11 offset:18432
ds_read_b128 v[56:59], v11 offset:14336
ds_read_b128 v[60:63], v11 offset:19456
ds_read_b128 v[64:67], v11 offset:25600
ds_read_b128 v[68:71], v11 offset:20480
ds_read_b128 v[72:75], v11 offset:26624
ds_read_b128 v[76:79], v11 offset:28672
ds_read_b128 v[80:83], v11 offset:24576
ds_read_b128 v[84:87], v11 offset:29696
ds_read_b128 v[88:91], v11 offset:35840
ds_read_b128 v[92:95], v11 offset:30720
ds_read_b128 v[96:99], v11 offset:36864
ds_read_b128 v[100:103], v11 offset:38912
ds_read_b128 v[104:107], v11 offset:34816
ds_read_b128 v[108:111], v11 offset:39936
s_waitcnt lgkmcnt(15)
v_mfma_f32_16x16x32_bf16 v[112:115], v[16:19], v[20:23], 0
v_mfma_f32_16x16x32_bf16 v[116:119], v[24:27], v[20:23], 0
v_mfma_f32_16x16x32_bf16 v[120:123], v[140:143], v[20:23], 0
v_mfma_f32_16x16x32_bf16 v[124:127], v[28:31], v[32:35], 0
v_mfma_f32_16x16x32_bf16 v[128:131], v[36:39], v[32:35], 0
s_waitcnt lgkmcnt(12)
v_mfma_f32_16x16x32_bf16 v[112:115], v[40:43], v[44:47], v[112:115]
v_mfma_f32_16x16x32_bf16 v[116:119], v[48:51], v[44:47], v[116:119]
v_mfma_f32_16x16x32_bf16 v[120:123], v[140:143], v[44:47], v[120:123]
v_mfma_f32_16x16x32_bf16 v[124:127], v[52:55], v[56:59], v[124:127]
v_mfma_f32_16x16x32_bf16 v[128:131], v[60:63], v[56:59], v[128:131]
s_waitcnt lgkmcnt(6)
v_mfma_f32_16x16x32_bf16 v[112:115], v[64:67], v[68:71], v[112:115]
v_mfma_f32_16x16x32_bf16 v[116:119], v[72:75], v[68:71], v[116:119]
v_mfma_f32_16x16x32_bf16 v[120:123], v[140:143], v[68:71], v[120:123]
v_mfma_f32_16x16x32_bf16 v[124:127], v[76:79], v[80:83], v[124:127]
v_mfma_f32_16x16x32_bf16 v[128:131], v[84:87], v[80:83], v[128:131]
s_waitcnt lgkmcnt(0)
v_mfma_f32_16x16x32_bf16 v[112:115], v[88:91], v[92:95], v[112:115]
v_mfma_f32_16x16x32_bf16 v[116:119], v[96:99], v[92:95], v[116:119]
v_mfma_f32_16x16x32_bf16 v[120:123], v[140:143], v[92:95], v[120:123]
v_mfma_f32_16x16x32_bf16 v[124:127], v[100:103], v[104:107], v[124:127]
v_mfma_f32_16x16x32_bf16 v[128:131], v[108:111], v[104:107], v[128:131]
s_nop 3
v_cvt_pk_bf16_f32 v16, v112, v113
v_cvt_pk_bf16_f32 v17, v114, v115
v_cvt_pk_bf16_f32 v18, v116, v117
v_cvt_pk_bf16_f32 v19, v118, v119
s_add_u32 s44, s38, 0
buffer_store_dwordx4 v[16:19], v11, s[16:19], s44 offen sc1
s_mov_b64 exec, 0xffffffff
buffer_store_dword v120, v15, s[16:19], s39 offen offset:0 sc1
s_mov_b64 exec, -1
v_cvt_pk_bf16_f32 v20, v124, v125
v_cvt_pk_bf16_f32 v21, v126, v127
v_cvt_pk_bf16_f32 v22, v128, v129
v_cvt_pk_bf16_f32 v23, v130, v131
s_add_u32 s44, s38, 8192
buffer_store_dwordx4 v[20:23], v11, s[16:19], s44 offen sc1
s_nop 1
s_branch k1_kvend
k1_kvw1:
ds_read_b128 v[16:19], v11 offset:5120
ds_read_b128 v[20:23], v11 offset:1024
ds_read_b128 v[24:27], v11 offset:6144
ds_read_b128 v[28:31], v11 offset:7168
ds_read_b128 v[40:43], v11 offset:15360
ds_read_b128 v[44:47], v11 offset:11264
ds_read_b128 v[48:51], v11 offset:16384
ds_read_b128 v[52:55], v11 offset:17408
ds_read_b128 v[64:67], v11 offset:25600
ds_read_b128 v[68:71], v11 offset:21504
ds_read_b128 v[72:75], v11 offset:26624
ds_read_b128 v[76:79], v11 offset:27648
ds_read_b128 v[88:91], v11 offset:35840
ds_read_b128 v[92:95], v11 offset:31744
ds_read_b128 v[96:99], v11 offset:36864
ds_read_b128 v[100:103], v11 offset:37888
s_waitcnt lgkmcnt(12)
v_mfma_f32_16x16x32_bf16 v[112:115], v[16:19], v[20:23], 0
v_mfma_f32_16x16x32_bf16 v[116:119], v[24:27], v[20:23], 0
v_mfma_f32_16x16x32_bf16 v[120:123], v[28:31], v[20:23], 0
v_mfma_f32_16x16x32_bf16 v[124:127], v[140:143], v[20:23], 0
s_waitcnt lgkmcnt(8)
v_mfma_f32_16x16x32_bf16 v[112:115], v[40:43], v[44:47], v[112:115]
v_mfma_f32_16x16x32_bf16 v[116:119], v[48:51], v[44:47], v[116:119]
v_mfma_f32_16x16x32_bf16 v[120:123], v[52:55], v[44:47], v[120:123]
v_mfma_f32_16x16x32_bf16 v[124:127], v[140:143], v[44:47], v[124:127]
s_waitcnt lgkmcnt(4)
v_mfma_f32_16x16x32_bf16 v[112:115], v[64:67], v[68:71], v[112:115]
v_mfma_f32_16x16x32_bf16 v[116:119], v[72:75], v[68:71], v[116:119]
v_mfma_f32_16x16x32_bf16 v[120:123], v[76:79], v[68:71], v[120:123]
v_mfma_f32_16x16x32_bf16 v[124:127], v[140:143], v[68:71], v[124:127]
s_waitcnt lgkmcnt(0)
v_mfma_f32_16x16x32_bf16 v[112:115], v[88:91], v[92:95], v[112:115]
v_mfma_f32_16x16x32_bf16 v[116:119], v[96:99], v[92:95], v[116:119]
v_mfma_f32_16x16x32_bf16 v[120:123], v[100:103], v[92:95], v[120:123]
v_mfma_f32_16x16x32_bf16 v[124:127], v[140:143], v[92:95], v[124:127]
s_nop 4
v_cvt_pk_bf16_f32 v16, v112, v113
v_cvt_pk_bf16_f32 v17, v114, v115
v_cvt_pk_bf16_f32 v18, v116, v117
v_cvt_pk_bf16_f32 v19, v118, v119
s_add_u32 s44, s38, 2048
buffer_store_dwordx4 v[16:19], v11, s[16:19], s44 offen sc1
s_mov_b64 exec, 0xffffffff
buffer_store_dword v124, v15, s[16:19], s39 offen offset:128 sc1
s_mov_b64 exec, -1
v_cvt_pk_bf16_f32 v20, v120, v121
v_cvt_pk_bf16_f32 v21, v122, v123
s_add_u32 s44, s38, 3072
buffer_store_dwordx4 v[20:23], v11, s[16:19], s44 offen sc1
s_nop 1
s_branch k1_kvend
k1_kvw2:
ds_read_b128 v[16:19], v11 offset:6144
ds_read_b128 v[20:23], v11 offset:2048
ds_read_b128 v[24:27], v11 offset:7168
ds_read_b128 v[28:31], v11 offset:8192
ds_read_b128 v[40:43], v11 offset:16384
ds_read_b128 v[44:47], v11 offset:12288
ds_read_b128 v[48:51], v11 offset:17408
ds_read_b128 v[52:55], v11 offset:18432
ds_read_b128 v[64:67], v11 offset:26624
ds_read_b128 v[68:71], v11 offset:22528
ds_read_b128 v[72:75], v11 offset:27648
ds_read_b128 v[76:79], v11 offset:28672
ds_read_b128 v[88:91], v11 offset:36864
ds_read_b128 v[92:95], v11 offset:32768
ds_read_b128 v[96:99], v11 offset:37888
ds_read_b128 v[100:103], v11 offset:38912
s_waitcnt lgkmcnt(12)
v_mfma_f32_16x16x32_bf16 v[112:115], v[16:19], v[20:23], 0
v_mfma_f32_16x16x32_bf16 v[116:119], v[24:27], v[20:23], 0
v_mfma_f32_16x16x32_bf16 v[120:123], v[28:31], v[20:23], 0
v_mfma_f32_16x16x32_bf16 v[124:127], v[140:143], v[20:23], 0
s_waitcnt lgkmcnt(8)
v_mfma_f32_16x16x32_bf16 v[112:115], v[40:43], v[44:47], v[112:115]
v_mfma_f32_16x16x32_bf16 v[116:119], v[48:51], v[44:47], v[116:119]
v_mfma_f32_16x16x32_bf16 v[120:123], v[52:55], v[44:47], v[120:123]
v_mfma_f32_16x16x32_bf16 v[124:127], v[140:143], v[44:47], v[124:127]
s_waitcnt lgkmcnt(4)
v_mfma_f32_16x16x32_bf16 v[112:115], v[64:67], v[68:71], v[112:115]
v_mfma_f32_16x16x32_bf16 v[116:119], v[72:75], v[68:71], v[116:119]
v_mfma_f32_16x16x32_bf16 v[120:123], v[76:79], v[68:71], v[120:123]
v_mfma_f32_16x16x32_bf16 v[124:127], v[140:143], v[68:71], v[124:127]
s_waitcnt lgkmcnt(0)
v_mfma_f32_16x16x32_bf16 v[112:115], v[88:91], v[92:95], v[112:115]
v_mfma_f32_16x16x32_bf16 v[116:119], v[96:99], v[92:95], v[116:119]
v_mfma_f32_16x16x32_bf16 v[120:123], v[100:103], v[92:95], v[120:123]
v_mfma_f32_16x16x32_bf16 v[124:127], v[140:143], v[92:95], v[124:127]
s_nop 4
v_cvt_pk_bf16_f32 v16, v112, v113
v_cvt_pk_bf16_f32 v17, v114, v115
v_cvt_pk_bf16_f32 v18, v116, v117
v_cvt_pk_bf16_f32 v19, v118, v119
s_add_u32 s44, s38, 4096
buffer_store_dwordx4 v[16:19], v11, s[16:19], s44 offen sc1
s_mov_b64 exec, 0xffffffff
buffer_store_dword v124, v15, s[16:19], s39 offen offset:256 sc1
s_mov_b64 exec, -1
v_cvt_pk_bf16_f32 v20, v120, v121
v_cvt_pk_bf16_f32 v21, v122, v123
s_add_u32 s44, s38, 5120
buffer_store_dwordx4 v[20:23], v11, s[16:19], s44 offen sc1
s_nop 1
s_branch k1_kvend
k1_kvend:
v_mov_b32 v12, 151552
v_mov_b32 v13, 1
v_lshrrev_b32 v14, 3, v1
v_and_b32 v152, 7, v1
v_lshlrev_b32 v152, 4, v152
v_lshl_add_u32 v14, v14, 15, v152
s_mov_b32 s52, 0
s_nop 0
k1_tk18:
s_waitcnt vmcnt(0)
v_readfirstlane_b32 s50, v148
v_readfirstlane_b32 s51, v149
s_add_u32 s52, s52, 1
s_xor_b32 s53, s50, s51
s_cmp_eq_u32 s53, -1
s_nop 1
s_cbranch_scc1 k1_tk19
buffer_load_dwordx2 v[148:149], off, s[64:67], 0 sc1
s_cmp_lt_u32 s52, 32768
s_cbranch_scc1 k1_tk18
k1_tk19:
s_mov_b64 exec, 1
ds_add_rtn_u32 v13, v12, v13
s_mov_b64 exec, -1
v_mov_b32 v152, s50
v_mov_b32 v153, s51
v_mov_b32 v154, s50
v_mov_b32 v155, s51
s_waitcnt lgkmcnt(0)
v_readfirstlane_b32 s53, v13
s_cmp_lg_u32 s53, 3
s_nop 3
s_cbranch_scc1 k1_sg17
buffer_store_dwordx4 v[152:155], v14, s[16:19], s45 offen sc1
s_nop 1
k1_sg17:
s_endpgm
k1_q:
s_mov_b32 s49, -73728
v_lshrrev_b32 v15, 1, v14
v_xor_b32 v15, v15, v14
v_and_b32 v15, 1, v15
v_mul_u32_u24 v15, 5, v15
v_mul_u32_u24 v8, 10, v14
v_add_u32 v9, 0, v14
v_lshrrev_b32 v10, 3, v9
v_and_b32 v9, 7, v9
v_lshl_add_u32 v10, v10, 12, v12
v_lshlrev_b32 v9, 3, v9
v_xor_b32 v9, v9, v13
v_add_u32 v96, v9, v10
v_add_u32 v9, 5, v14
v_lshrrev_b32 v10, 3, v9
v_and_b32 v9, 7, v9
v_lshl_add_u32 v10, v10, 12, v12
v_lshlrev_b32 v9, 3, v9
v_xor_b32 v9, v9, v13
v_add_u32 v97, v9, v10
v_add_u32 v9, 10, v14
v_lshrrev_b32 v10, 3, v9
v_and_b32 v9, 7, v9
v_lshl_add_u32 v10, v10, 12, v12
v_lshlrev_b32 v9, 3, v9
v_xor_b32 v9, v9, v13
v_add_u32 v98, v9, v10
v_add_u32 v9, 15, v14
v_lshrrev_b32 v10, 3, v9
v_and_b32 v9, 7, v9
v_lshl_add_u32 v10, v10, 12, v12
v_lshlrev_b32 v9, 3, v9
v_xor_b32 v9, v9, v13
v_add_u32 v99, v9, v10
v_add_u32 v9, 20, v14
v_lshrrev_b32 v10, 3, v9
v_and_b32 v9, 7, v9
v_lshl_add_u32 v10, v10, 12, v12
v_lshlrev_b32 v9, 3, v9
v_xor_b32 v9, v9, v13
v_add_u32 v100, v9, v10
v_add_u32 v9, 25, v14
v_lshrrev_b32 v10, 3, v9
v_and_b32 v9, 7, v9
v_lshl_add_u32 v10, v10, 12, v12
v_lshlrev_b32 v9, 3, v9
v_xor_b32 v9, v9, v13
v_add_u32 v101, v9, v10
v_add_u32 v9, 30, v14
v_lshrrev_b32 v10, 3, v9
v_and_b32 v9, 7, v9
v_lshl_add_u32 v10, v10, 12, v12
v_lshlrev_b32 v9, 3, v9
v_xor_b32 v9, v9, v13
v_add_u32 v102, v9, v10
v_add_u32 v9, 35, v14
v_lshrrev_b32 v10, 3, v9
v_and_b32 v9, 7, v9
v_lshl_add_u32 v10, v10, 12, v12
v_lshlrev_b32 v9, 3, v9
v_xor_b32 v9, v9, v13
v_add_u32 v103, v9, v10
v_add3_u32 v9, v8, v15, 4
v_lshrrev_b32 v10, 3, v9
v_and_b32 v9, 7, v9
v_lshl_add_u32 v10, v10, 12, v12
v_lshlrev_b32 v9, 3, v9
v_xor_b32 v9, v9, v13
v_add_u32 v104, v9, v10
v_sub_u32 v9, v8, v15
v_add_u32 v9, 9, v9
v_lshrrev_b32 v10, 3, v9
v_and_b32 v9, 7, v9
v_lshl_add_u32 v10, v10, 12, v12
v_lshlrev_b32 v9, 3, v9
v_xor_b32 v9, v9, v13
v_add_u32 v105, v9, v10
s_lshl_b32 s46, s22, 10
v_lshl_add_u32 v12, v2, 3, s46
v_add_u32 v13, 512, v12
v_and_b32 v14, 3, v3
v_cmp_eq_u32 vcc, 0, v14
s_nop 1
v_cndmask_b32 v144, v13, v12, vcc
v_cmp_eq_u32 vcc, 1, v14
s_nop 1
v_cndmask_b32 v145, v13, v12, vcc
v_cmp_eq_u32 vcc, 2, v14
s_nop 1
v_cndmask_b32 v146, v13, v12, vcc
v_cmp_eq_u32 vcc, 3, v14
s_nop 1
v_cndmask_b32 v147, v13, v12, vcc
v_lshrrev_b32 v15, 1, v2
v_xor_b32 v15, v15, v2
v_and_b32 v15, 1, v15
v_lshl_add_u32 v8, v2, 1, v15
v_mul_u32_u24 v9, 40, v8
v_add3_u32 v9, v9, s46, 32
v_add_u32 v10, 0, v14
v_cmp_eq_u32 vcc, v10, v8
s_nop 1
v_cndmask_b32 v148, v13, v9, vcc
v_add_u32 v10, 4, v14
v_cmp_eq_u32 vcc, v10, v8
s_nop 1
v_cndmask_b32 v150, v13, v9, vcc
v_xor_b32 v15, 1, v15
v_lshl_add_u32 v8, v2, 1, v15
v_mul_u32_u24 v9, 40, v8
v_add3_u32 v9, v9, s46, 32
v_add_u32 v10, 0, v14
v_cmp_eq_u32 vcc, v10, v8
s_nop 1
v_cndmask_b32 v149, v13, v9, vcc
v_add_u32 v10, 4, v14
v_cmp_eq_u32 vcc, v10, v8
s_nop 1
v_cndmask_b32 v151, v13, v9, vcc
v_mov_b32 v152, 0x358637bd
v_mov_b32 v153, 0x358637bd
v_mov_b32 v154, 0x358637bd
v_mov_b32 v155, 0x358637bd
s_lshl_b32 s38, s21, 12
s_add_u32 s38, s38, 8192
v_lshlrev_b32 v8, 11, v2
v_lshl_add_u32 v8, v3, 7, v8
v_add_u32 v8, s38, v8
s_lshl_b32 s38, s20, 7
v_lshl_add_u32 v9, v14, 11, s38
v_cmp_gt_u32 vcc, 32, v1
s_nop 1
v_cndmask_b32 v158, v9, v8, vcc
s_lshl_b32 s45, s32, 15
s_add_u32 s45, s45, 12197888
v_mov_b32 v159, 151552
v_min_u32 v8, 39, v1
v_lshl_add_u32 v9, v8, 3, s46
v_lshrrev_b32 v10, 2, v8
v_lshlrev_b32 v8, 4, v8
v_lshl_add_u32 v8, v10, 6, v8
v_lshlrev_b32 v10, 2, v3
v_add_u32 v5, 4096, v11
s_mul_i32 s38, s29, 40960
s_mul_i32 s39, s21, 5120
s_add_u32 s38, s38, s39
s_add_u32 s39, s38, 20480
s_lshl_b32 s24, s29, 7
s_add_u32 s26, s24, 12091392
s_lshl_b32 s24, s24, 1
s_add_u32 s25, s24, 12173312
s_add_u32 s24, s24, 12156928
s_mul_i32 s27, s21, 1280
s_add_u32 s27, s27, 10485760
s_mov_b32 s54, 0xffff0000
s_mov_b32 s55, 0xffff0000
s_mov_b32 s58, 0
s_mov_b32 s59, -1
s_waitcnt lgkmcnt(0)
s_barrier
ds_read_b128 v[160:163], v6 offset:0
ds_read_b64_tr_b16 v[176:177], v96 offset:0
ds_read_b64_tr_b16 v[178:179], v96 offset:256
ds_read_b128 v[164:167], v6 offset:2048
ds_read_b64_tr_b16 v[180:181], v97 offset:0
ds_read_b64_tr_b16 v[182:183], v97 offset:256
ds_read_b64_tr_b16 v[184:185], v98 offset:0
ds_read_b64_tr_b16 v[186:187], v98 offset:256
ds_read_b64_tr_b16 v[188:189], v99 offset:0
ds_read_b64_tr_b16 v[190:191], v99 offset:256
ds_read_b64_tr_b16 v[192:193], v100 offset:0
ds_read_b64_tr_b16 v[194:195], v100 offset:256
ds_read_b64_tr_b16 v[196:197], v101 offset:0
ds_read_b64_tr_b16 v[198:199], v101 offset:256
ds_read_b64_tr_b16 v[200:201], v102 offset:0
ds_read_b64_tr_b16 v[202:203], v102 offset:256
ds_read_b64_tr_b16 v[204:205], v103 offset:0
ds_read_b64_tr_b16 v[206:207], v103 offset:256
ds_read_b64_tr_b16 v[208:209], v104 offset:0
ds_read_b64_tr_b16 v[210:211], v104 offset:256
ds_read_b64_tr_b16 v[212:213], v105 offset:0
ds_read_b64_tr_b16 v[214:215], v105 offset:256
k1_qloop:
s_waitcnt lgkmcnt(10)
v_mfma_f32_16x16x32_bf16 v[16:19], v[176:179], v[160:163], v[16:19]
ds_read_b128 v[168:171], v7 offset:0
ds_read_b64_tr_b16 v[216:217], v96 offset:2048
v_mfma_f32_16x16x32_bf16 v[20:23], v[176:179], v[164:167], v[20:23]
ds_read_b64_tr_b16 v[218:219], v96 offset:2304
ds_read_b128 v[172:175], v7 offset:2048
v_mfma_f32_16x16x32_bf16 v[24:27], v[180:183], v[160:163], v[24:27]
ds_read_b64_tr_b16 v[220:221], v97 offset:2048
v_mfma_f32_16x16x32_bf16 v[28:31], v[180:183], v[164:167], v[28:31]
ds_read_b64_tr_b16 v[222:223], v97 offset:2304
v_mfma_f32_16x16x32_bf16 v[32:35], v[184:187], v[160:163], v[32:35]
ds_read_b64_tr_b16 v[224:225], v98 offset:2048
v_mfma_f32_16x16x32_bf16 v[36:39], v[184:187], v[164:167], v[36:39]
ds_read_b64_tr_b16 v[226:227], v98 offset:2304
v_mfma_f32_16x16x32_bf16 v[40:43], v[188:191], v[160:163], v[40:43]
ds_read_b64_tr_b16 v[228:229], v99 offset:2048
v_mfma_f32_16x16x32_bf16 v[44:47], v[188:191], v[164:167], v[44:47]
ds_read_b64_tr_b16 v[230:231], v99 offset:2304
v_mfma_f32_16x16x32_bf16 v[48:51], v[192:195], v[160:163], v[48:51]
ds_read_b64_tr_b16 v[232:233], v100 offset:2048
v_mfma_f32_16x16x32_bf16 v[52:55], v[192:195], v[164:167], v[52:55]
ds_read_b64_tr_b16 v[234:235], v100 offset:2304
s_waitcnt lgkmcnt(12)
v_mfma_f32_16x16x32_bf16 v[56:59], v[196:199], v[160:163], v[56:59]
ds_read_b64_tr_b16 v[236:237], v101 offset:2048
v_mfma_f32_16x16x32_bf16 v[60:63], v[196:199], v[164:167], v[60:63]
ds_read_b64_tr_b16 v[238:239], v101 offset:2304
v_mfma_f32_16x16x32_bf16 v[64:67], v[200:203], v[160:163], v[64:67]
ds_read_b64_tr_b16 v[240:241], v102 offset:2048
v_mfma_f32_16x16x32_bf16 v[68:71], v[200:203], v[164:167], v[68:71]
ds_read_b64_tr_b16 v[242:243], v102 offset:2304
v_mfma_f32_16x16x32_bf16 v[72:75], v[204:207], v[160:163], v[72:75]
ds_read_b64_tr_b16 v[244:245], v103 offset:2048
v_mfma_f32_16x16x32_bf16 v[76:79], v[204:207], v[164:167], v[76:79]
ds_read_b64_tr_b16 v[246:247], v103 offset:2304
v_mfma_f32_16x16x32_bf16 v[80:83], v[208:211], v[160:163], v[80:83]
ds_read_b64_tr_b16 v[248:249], v104 offset:2048
v_mfma_f32_16x16x32_bf16 v[84:87], v[208:211], v[164:167], v[84:87]
ds_read_b64_tr_b16 v[250:251], v104 offset:2304
v_mfma_f32_16x16x32_bf16 v[88:91], v[212:215], v[160:163], v[88:91]
ds_read_b64_tr_b16 v[252:253], v105 offset:2048
v_mfma_f32_16x16x32_bf16 v[92:95], v[212:215], v[164:167], v[92:95]
ds_read_b64_tr_b16 v[254:255], v105 offset:2304
s_waitcnt lgkmcnt(10)
v_mfma_f32_16x16x32_bf16 v[16:19], v[216:219], v[168:171], v[16:19]
s_sub_u32 s49, 0, s49
v_mfma_f32_16x16x32_bf16 v[20:23], v[216:219], v[172:175], v[20:23]
v_mfma_f32_16x16x32_bf16 v[24:27], v[220:223], v[168:171], v[24:27]
v_mfma_f32_16x16x32_bf16 v[28:31], v[220:223], v[172:175], v[28:31]
s_waitcnt lgkmcnt(0)
s_barrier
v_mfma_f32_16x16x32_bf16 v[32:35], v[224:227], v[168:171], v[32:35]
ds_read_b128 v[160:163], v6 offset:36864
ds_read_b64_tr_b16 v[176:177], v96 offset:36864
v_mfma_f32_16x16x32_bf16 v[36:39], v[224:227], v[172:175], v[36:39]
ds_read_b64_tr_b16 v[178:179], v96 offset:37120
ds_read_b128 v[164:167], v6 offset:38912
v_mfma_f32_16x16x32_bf16 v[40:43], v[228:231], v[168:171], v[40:43]
ds_read_b64_tr_b16 v[180:181], v97 offset:36864
ds_read_b64_tr_b16 v[182:183], v97 offset:37120
v_mfma_f32_16x16x32_bf16 v[44:47], v[228:231], v[172:175], v[44:47]
ds_read_b64_tr_b16 v[184:185], v98 offset:36864
ds_read_b64_tr_b16 v[186:187], v98 offset:37120
v_mfma_f32_16x16x32_bf16 v[48:51], v[232:235], v[168:171], v[48:51]
ds_read_b64_tr_b16 v[188:189], v99 offset:36864
ds_read_b64_tr_b16 v[190:191], v99 offset:37120
v_mfma_f32_16x16x32_bf16 v[52:55], v[232:235], v[172:175], v[52:55]
ds_read_b64_tr_b16 v[192:193], v100 offset:36864
ds_read_b64_tr_b16 v[194:195], v100 offset:37120
v_mfma_f32_16x16x32_bf16 v[56:59], v[236:239], v[168:171], v[56:59]
ds_read_b64_tr_b16 v[196:197], v101 offset:36864
ds_read_b64_tr_b16 v[198:199], v101 offset:37120
v_mfma_f32_16x16x32_bf16 v[60:63], v[236:239], v[172:175], v[60:63]
ds_read_b64_tr_b16 v[200:201], v102 offset:36864
ds_read_b64_tr_b16 v[202:203], v102 offset:37120
v_mfma_f32_16x16x32_bf16 v[64:67], v[240:243], v[168:171], v[64:67]
ds_read_b64_tr_b16 v[204:205], v103 offset:36864
ds_read_b64_tr_b16 v[206:207], v103 offset:37120
v_mfma_f32_16x16x32_bf16 v[68:71], v[240:243], v[172:175], v[68:71]
ds_read_b64_tr_b16 v[208:209], v104 offset:36864
ds_read_b64_tr_b16 v[210:211], v104 offset:37120
v_mfma_f32_16x16x32_bf16 v[72:75], v[244:247], v[168:171], v[72:75]
ds_read_b64_tr_b16 v[212:213], v105 offset:36864
ds_read_b64_tr_b16 v[214:215], v105 offset:37120
v_mfma_f32_16x16x32_bf16 v[76:79], v[244:247], v[172:175], v[76:79]
v_mfma_f32_16x16x32_bf16 v[80:83], v[248:251], v[168:171], v[80:83]
v_mfma_f32_16x16x32_bf16 v[84:87], v[248:251], v[172:175], v[84:87]
v_mfma_f32_16x16x32_bf16 v[88:91], v[252:255], v[168:171], v[88:91]
v_mfma_f32_16x16x32_bf16 v[92:95], v[252:255], v[172:175], v[92:95]
s_waitcnt lgkmcnt(10)
v_mfma_f32_16x16x32_bf16 v[16:19], v[176:179], v[160:163], v[16:19]
ds_read_b128 v[168:171], v7 offset:36864
ds_read_b64_tr_b16 v[216:217], v96 offset:38912
v_mfma_f32_16x16x32_bf16 v[20:23], v[176:179], v[164:167], v[20:23]
ds_read_b64_tr_b16 v[218:219], v96 offset:39168
ds_read_b128 v[172:175], v7 offset:38912
v_mfma_f32_16x16x32_bf16 v[24:27], v[180:183], v[160:163], v[24:27]
ds_read_b64_tr_b16 v[220:221], v97 offset:38912
v_mfma_f32_16x16x32_bf16 v[28:31], v[180:183], v[164:167], v[28:31]
ds_read_b64_tr_b16 v[222:223], v97 offset:39168
v_mfma_f32_16x16x32_bf16 v[32:35], v[184:187], v[160:163], v[32:35]
ds_read_b64_tr_b16 v[224:225], v98 offset:38912
v_mfma_f32_16x16x32_bf16 v[36:39], v[184:187], v[164:167], v[36:39]
ds_read_b64_tr_b16 v[226:227], v98 offset:39168
v_mfma_f32_16x16x32_bf16 v[40:43], v[188:191], v[160:163], v[40:43]
ds_read_b64_tr_b16 v[228:229], v99 offset:38912
v_mfma_f32_16x16x32_bf16 v[44:47], v[188:191], v[164:167], v[44:47]
ds_read_b64_tr_b16 v[230:231], v99 offset:39168
v_mfma_f32_16x16x32_bf16 v[48:51], v[192:195], v[160:163], v[48:51]
ds_read_b64_tr_b16 v[232:233], v100 offset:38912
v_mfma_f32_16x16x32_bf16 v[52:55], v[192:195], v[164:167], v[52:55]
ds_read_b64_tr_b16 v[234:235], v100 offset:39168
s_waitcnt lgkmcnt(12)
v_mfma_f32_16x16x32_bf16 v[56:59], v[196:199], v[160:163], v[56:59]
ds_read_b64_tr_b16 v[236:237], v101 offset:38912
v_mfma_f32_16x16x32_bf16 v[60:63], v[196:199], v[164:167], v[60:63]
ds_read_b64_tr_b16 v[238:239], v101 offset:39168
v_mfma_f32_16x16x32_bf16 v[64:67], v[200:203], v[160:163], v[64:67]
ds_read_b64_tr_b16 v[240:241], v102 offset:38912
v_mfma_f32_16x16x32_bf16 v[68:71], v[200:203], v[164:167], v[68:71]
ds_read_b64_tr_b16 v[242:243], v102 offset:39168
v_mfma_f32_16x16x32_bf16 v[72:75], v[204:207], v[160:163], v[72:75]
ds_read_b64_tr_b16 v[244:245], v103 offset:38912
v_mfma_f32_16x16x32_bf16 v[76:79], v[204:207], v[164:167], v[76:79]
ds_read_b64_tr_b16 v[246:247], v103 offset:39168
v_mfma_f32_16x16x32_bf16 v[80:83], v[208:211], v[160:163], v[80:83]
ds_read_b64_tr_b16 v[248:249], v104 offset:38912
v_mfma_f32_16x16x32_bf16 v[84:87], v[208:211], v[164:167], v[84:87]
ds_read_b64_tr_b16 v[250:251], v104 offset:39168
v_mfma_f32_16x16x32_bf16 v[88:91], v[212:215], v[160:163], v[88:91]
ds_read_b64_tr_b16 v[252:253], v105 offset:38912
v_mfma_f32_16x16x32_bf16 v[92:95], v[212:215], v[164:167], v[92:95]
ds_read_b64_tr_b16 v[254:255], v105 offset:39168
s_waitcnt lgkmcnt(10)
v_mfma_f32_16x16x32_bf16 v[16:19], v[216:219], v[168:171], v[16:19]
v_add_u32 v6, s49, v6
v_add_u32 v7, s49, v7
v_mfma_f32_16x16x32_bf16 v[20:23], v[216:219], v[172:175], v[20:23]
s_sub_u32 s44, s44, 1
s_cmp_lg_u32 s44, 0
v_mfma_f32_16x16x32_bf16 v[24:27], v[220:223], v[168:171], v[24:27]
v_mfma_f32_16x16x32_bf16 v[28:31], v[220:223], v[172:175], v[28:31]
s_waitcnt lgkmcnt(0)
s_barrier
v_mfma_f32_16x16x32_bf16 v[32:35], v[224:227], v[168:171], v[32:35]
ds_read_b128 v[160:163], v6 offset:0
v_add_u32 v96, s49, v96
v_mfma_f32_16x16x32_bf16 v[36:39], v[224:227], v[172:175], v[36:39]
ds_read_b64_tr_b16 v[176:177], v96 offset:0
ds_read_b64_tr_b16 v[178:179], v96 offset:256
v_mfma_f32_16x16x32_bf16 v[40:43], v[228:231], v[168:171], v[40:43]
ds_read_b128 v[164:167], v6 offset:2048
v_add_u32 v97, s49, v97
v_mfma_f32_16x16x32_bf16 v[44:47], v[228:231], v[172:175], v[44:47]
ds_read_b64_tr_b16 v[180:181], v97 offset:0
ds_read_b64_tr_b16 v[182:183], v97 offset:256
v_mfma_f32_16x16x32_bf16 v[48:51], v[232:235], v[168:171], v[48:51]
v_add_u32 v98, s49, v98
ds_read_b64_tr_b16 v[184:185], v98 offset:0
v_mfma_f32_16x16x32_bf16 v[52:55], v[232:235], v[172:175], v[52:55]
ds_read_b64_tr_b16 v[186:187], v98 offset:256
v_add_u32 v99, s49, v99
v_mfma_f32_16x16x32_bf16 v[56:59], v[236:239], v[168:171], v[56:59]
ds_read_b64_tr_b16 v[188:189], v99 offset:0
ds_read_b64_tr_b16 v[190:191], v99 offset:256
v_mfma_f32_16x16x32_bf16 v[60:63], v[236:239], v[172:175], v[60:63]
v_add_u32 v100, s49, v100
ds_read_b64_tr_b16 v[192:193], v100 offset:0
v_mfma_f32_16x16x32_bf16 v[64:67], v[240:243], v[168:171], v[64:67]
ds_read_b64_tr_b16 v[194:195], v100 offset:256
v_add_u32 v101, s49, v101
v_mfma_f32_16x16x32_bf16 v[68:71], v[240:243], v[172:175], v[68:71]
ds_read_b64_tr_b16 v[196:197], v101 offset:0
ds_read_b64_tr_b16 v[198:199], v101 offset:256
v_mfma_f32_16x16x32_bf16 v[72:75], v[244:247], v[168:171], v[72:75]
v_add_u32 v102, s49, v102
ds_read_b64_tr_b16 v[200:201], v102 offset:0
v_mfma_f32_16x16x32_bf16 v[76:79], v[244:247], v[172:175], v[76:79]
ds_read_b64_tr_b16 v[202:203], v102 offset:256
v_add_u32 v103, s49, v103
v_mfma_f32_16x16x32_bf16 v[80:83], v[248:251], v[168:171], v[80:83]
ds_read_b64_tr_b16 v[204:205], v103 offset:0
ds_read_b64_tr_b16 v[206:207], v103 offset:256
v_mfma_f32_16x16x32_bf16 v[84:87], v[248:251], v[172:175], v[84:87]
v_add_u32 v104, s49, v104
ds_read_b64_tr_b16 v[208:209], v104 offset:0
v_mfma_f32_16x16x32_bf16 v[88:91], v[252:255], v[168:171], v[88:91]
ds_read_b64_tr_b16 v[210:211], v104 offset:256
v_add_u32 v105, s49, v105
v_mfma_f32_16x16x32_bf16 v[92:95], v[252:255], v[172:175], v[92:95]
ds_read_b64_tr_b16 v[212:213], v105 offset:0
ds_read_b64_tr_b16 v[214:215], v105 offset:256
s_cbranch_scc1 k1_qloop
buffer_load_dwordx2 v[156:157], off, s[64:67], 0 sc1
v_mov_b32 v12, 0
v_mov_b32 v13, 0
ds_write_b64 v9, v[12:13] offset:512
v_pk_fma_f32 v[136:137], v[16:17], s[40:41], s[40:41] neg_lo:[0,0,1] neg_hi:[0,0,1]
v_pk_fma_f32 v[138:139], v[18:19], s[40:41], s[40:41] neg_lo:[0,0,1] neg_hi:[0,0,1]
v_pk_fma_f32 v[140:141], v[24:25], s[40:41], s[40:41] neg_lo:[0,0,1] neg_hi:[0,0,1]
v_pk_fma_f32 v[142:143], v[26:27], s[40:41], s[40:41] neg_lo:[0,0,1] neg_hi:[0,0,1]
v_exp_f32_e64 v136, v136 clamp
v_exp_f32_e64 v137, v137 clamp
v_exp_f32_e64 v138, v138 clamp
v_exp_f32_e64 v139, v139 clamp
v_exp_f32_e64 v140, v140 clamp
v_exp_f32_e64 v141, v141 clamp
v_exp_f32_e64 v142, v142 clamp
v_exp_f32_e64 v143, v143 clamp
v_max_f32 v16, v16, v136
v_max_f32 v17, v17, v137
v_max_f32 v18, v18, v138
v_max_f32 v19, v19, v139
v_max_f32 v24, v24, v140
v_max_f32 v25, v25, v141
v_max_f32 v26, v26, v142
v_max_f32 v27, v27, v143
v_pk_add_f32 v[16:17], v[16:17], s[42:43]
v_pk_add_f32 v[18:19], v[18:19], s[42:43]
v_pk_add_f32 v[24:25], v[24:25], s[42:43]
v_pk_add_f32 v[26:27], v[26:27], s[42:43]
v_cvt_pk_bf16_f32 v96, v16, v17
v_cvt_pk_bf16_f32 v97, v18, v19
v_cvt_pk_bf16_f32 v98, v24, v25
v_cvt_pk_bf16_f32 v99, v26, v27
v_pk_fma_f32 v[136:137], v[20:21], s[40:41], s[40:41] neg_lo:[0,0,1] neg_hi:[0,0,1]
v_pk_fma_f32 v[138:139], v[22:23], s[40:41], s[40:41] neg_lo:[0,0,1] neg_hi:[0,0,1]
v_pk_fma_f32 v[140:141], v[28:29], s[40:41], s[40:41] neg_lo:[0,0,1] neg_hi:[0,0,1]
v_pk_fma_f32 v[142:143], v[30:31], s[40:41], s[40:41] neg_lo:[0,0,1] neg_hi:[0,0,1]
v_exp_f32_e64 v136, v136 clamp
v_exp_f32_e64 v137, v137 clamp
v_exp_f32_e64 v138, v138 clamp
v_exp_f32_e64 v139, v139 clamp
v_exp_f32_e64 v140, v140 clamp
v_exp_f32_e64 v141, v141 clamp
v_exp_f32_e64 v142, v142 clamp
v_exp_f32_e64 v143, v143 clamp
v_max_f32 v20, v20, v136
v_max_f32 v21, v21, v137
v_max_f32 v22, v22, v138
v_max_f32 v23, v23, v139
v_max_f32 v28, v28, v140
v_max_f32 v29, v29, v141
v_max_f32 v30, v30, v142
v_max_f32 v31, v31, v143
v_pk_add_f32 v[20:21], v[20:21], s[42:43]
v_pk_add_f32 v[22:23], v[22:23], s[42:43]
v_pk_add_f32 v[28:29], v[28:29], s[42:43]
v_pk_add_f32 v[30:31], v[30:31], s[42:43]
v_cvt_pk_bf16_f32 v116, v20, v21
v_cvt_pk_bf16_f32 v117, v22, v23
v_cvt_pk_bf16_f32 v118, v28, v29
v_cvt_pk_bf16_f32 v119, v30, v31
v_pk_fma_f32 v[136:137], v[32:33], s[40:41], s[40:41] neg_lo:[0,0,1] neg_hi:[0,0,1]
v_pk_fma_f32 v[138:139], v[34:35], s[40:41], s[40:41] neg_lo:[0,0,1] neg_hi:[0,0,1]
v_pk_fma_f32 v[140:141], v[40:41], s[40:41], s[40:41] neg_lo:[0,0,1] neg_hi:[0,0,1]
v_pk_fma_f32 v[142:143], v[42:43], s[40:41], s[40:41] neg_lo:[0,0,1] neg_hi:[0,0,1]
v_exp_f32_e64 v136, v136 clamp
v_exp_f32_e64 v137, v137 clamp
v_exp_f32_e64 v138, v138 clamp
v_exp_f32_e64 v139, v139 clamp
v_exp_f32_e64 v140, v140 clamp
v_exp_f32_e64 v141, v141 clamp
v_exp_f32_e64 v142, v142 clamp
v_exp_f32_e64 v143, v143 clamp
v_max_f32 v32, v32, v136
v_max_f32 v33, v33, v137
v_max_f32 v34, v34, v138
v_max_f32 v35, v35, v139
v_max_f32 v40, v40, v140
v_max_f32 v41, v41, v141
v_max_f32 v42, v42, v142
v_max_f32 v43, v43, v143
v_pk_add_f32 v[32:33], v[32:33], s[42:43]
v_pk_add_f32 v[34:35], v[34:35], s[42:43]
v_pk_add_f32 v[40:41], v[40:41], s[42:43]
v_pk_add_f32 v[42:43], v[42:43], s[42:43]
v_cvt_pk_bf16_f32 v100, v32, v33
v_cvt_pk_bf16_f32 v101, v34, v35
v_cvt_pk_bf16_f32 v102, v40, v41
v_cvt_pk_bf16_f32 v103, v42, v43
v_pk_fma_f32 v[136:137], v[36:37], s[40:41], s[40:41] neg_lo:[0,0,1] neg_hi:[0,0,1]
v_pk_fma_f32 v[138:139], v[38:39], s[40:41], s[40:41] neg_lo:[0,0,1] neg_hi:[0,0,1]
v_pk_fma_f32 v[140:141], v[44:45], s[40:41], s[40:41] neg_lo:[0,0,1] neg_hi:[0,0,1]
v_pk_fma_f32 v[142:143], v[46:47], s[40:41], s[40:41] neg_lo:[0,0,1] neg_hi:[0,0,1]
v_exp_f32_e64 v136, v136 clamp
v_exp_f32_e64 v137, v137 clamp
v_exp_f32_e64 v138, v138 clamp
v_exp_f32_e64 v139, v139 clamp
v_exp_f32_e64 v140, v140 clamp
v_exp_f32_e64 v141, v141 clamp
v_exp_f32_e64 v142, v142 clamp
v_exp_f32_e64 v143, v143 clamp
v_max_f32 v36, v36, v136
v_max_f32 v37, v37, v137
v_max_f32 v38, v38, v138
v_max_f32 v39, v39, v139
v_max_f32 v44, v44, v140
v_max_f32 v45, v45, v141
v_max_f32 v46, v46, v142
v_max_f32 v47, v47, v143
v_pk_add_f32 v[36:37], v[36:37], s[42:43]
v_pk_add_f32 v[38:39], v[38:39], s[42:43]
v_pk_add_f32 v[44:45], v[44:45], s[42:43]
v_pk_add_f32 v[46:47], v[46:47], s[42:43]
v_cvt_pk_bf16_f32 v120, v36, v37
v_cvt_pk_bf16_f32 v121, v38, v39
v_cvt_pk_bf16_f32 v122, v44, v45
v_cvt_pk_bf16_f32 v123, v46, v47
v_pk_fma_f32 v[136:137], v[48:49], s[40:41], s[40:41] neg_lo:[0,0,1] neg_hi:[0,0,1]
v_pk_fma_f32 v[138:139], v[50:51], s[40:41], s[40:41] neg_lo:[0,0,1] neg_hi:[0,0,1]
v_pk_fma_f32 v[140:141], v[56:57], s[40:41], s[40:41] neg_lo:[0,0,1] neg_hi:[0,0,1]
v_pk_fma_f32 v[142:143], v[58:59], s[40:41], s[40:41] neg_lo:[0,0,1] neg_hi:[0,0,1]
v_exp_f32_e64 v136, v136 clamp
v_exp_f32_e64 v137, v137 clamp
v_exp_f32_e64 v138, v138 clamp
v_exp_f32_e64 v139, v139 clamp
v_exp_f32_e64 v140, v140 clamp
v_exp_f32_e64 v141, v141 clamp
v_exp_f32_e64 v142, v142 clamp
v_exp_f32_e64 v143, v143 clamp
v_max_f32 v48, v48, v136
v_max_f32 v49, v49, v137
v_max_f32 v50, v50, v138
v_max_f32 v51, v51, v139
v_max_f32 v56, v56, v140
v_max_f32 v57, v57, v141
v_max_f32 v58, v58, v142
v_max_f32 v59, v59, v143
v_pk_add_f32 v[48:49], v[48:49], s[42:43]
v_pk_add_f32 v[50:51], v[50:51], s[42:43]
v_pk_add_f32 v[56:57], v[56:57], s[42:43]
v_pk_add_f32 v[58:59], v[58:59], s[42:43]
v_cvt_pk_bf16_f32 v104, v48, v49
v_cvt_pk_bf16_f32 v105, v50, v51
v_cvt_pk_bf16_f32 v106, v56, v57
v_cvt_pk_bf16_f32 v107, v58, v59
v_pk_fma_f32 v[136:137], v[52:53], s[40:41], s[40:41] neg_lo:[0,0,1] neg_hi:[0,0,1]
v_pk_fma_f32 v[138:139], v[54:55], s[40:41], s[40:41] neg_lo:[0,0,1] neg_hi:[0,0,1]
v_pk_fma_f32 v[140:141], v[60:61], s[40:41], s[40:41] neg_lo:[0,0,1] neg_hi:[0,0,1]
v_pk_fma_f32 v[142:143], v[62:63], s[40:41], s[40:41] neg_lo:[0,0,1] neg_hi:[0,0,1]
v_exp_f32_e64 v136, v136 clamp
v_exp_f32_e64 v137, v137 clamp
v_exp_f32_e64 v138, v138 clamp
v_exp_f32_e64 v139, v139 clamp
v_exp_f32_e64 v140, v140 clamp
v_exp_f32_e64 v141, v141 clamp
v_exp_f32_e64 v142, v142 clamp
v_exp_f32_e64 v143, v143 clamp
v_max_f32 v52, v52, v136
v_max_f32 v53, v53, v137
v_max_f32 v54, v54, v138
v_max_f32 v55, v55, v139
v_max_f32 v60, v60, v140
v_max_f32 v61, v61, v141
v_max_f32 v62, v62, v142
v_max_f32 v63, v63, v143
v_pk_add_f32 v[52:53], v[52:53], s[42:43]
v_pk_add_f32 v[54:55], v[54:55], s[42:43]
v_pk_add_f32 v[60:61], v[60:61], s[42:43]
v_pk_add_f32 v[62:63], v[62:63], s[42:43]
v_cvt_pk_bf16_f32 v124, v52, v53
v_cvt_pk_bf16_f32 v125, v54, v55
v_cvt_pk_bf16_f32 v126, v60, v61
v_cvt_pk_bf16_f32 v127, v62, v63
v_pk_fma_f32 v[136:137], v[64:65], s[40:41], s[40:41] neg_lo:[0,0,1] neg_hi:[0,0,1]
v_pk_fma_f32 v[138:139], v[66:67], s[40:41], s[40:41] neg_lo:[0,0,1] neg_hi:[0,0,1]
v_pk_fma_f32 v[140:141], v[72:73], s[40:41], s[40:41] neg_lo:[0,0,1] neg_hi:[0,0,1]
v_pk_fma_f32 v[142:143], v[74:75], s[40:41], s[40:41] neg_lo:[0,0,1] neg_hi:[0,0,1]
v_exp_f32_e64 v136, v136 clamp
v_exp_f32_e64 v137, v137 clamp
v_exp_f32_e64 v138, v138 clamp
v_exp_f32_e64 v139, v139 clamp
v_exp_f32_e64 v140, v140 clamp
v_exp_f32_e64 v141, v141 clamp
v_exp_f32_e64 v142, v142 clamp
v_exp_f32_e64 v143, v143 clamp
v_max_f32 v64, v64, v136
v_max_f32 v65, v65, v137
v_max_f32 v66, v66, v138
v_max_f32 v67, v67, v139
v_max_f32 v72, v72, v140
v_max_f32 v73, v73, v141
v_max_f32 v74, v74, v142
v_max_f32 v75, v75, v143
v_pk_add_f32 v[64:65], v[64:65], s[42:43]
v_pk_add_f32 v[66:67], v[66:67], s[42:43]
v_pk_add_f32 v[72:73], v[72:73], s[42:43]
v_pk_add_f32 v[74:75], v[74:75], s[42:43]
v_cvt_pk_bf16_f32 v108, v64, v65
v_cvt_pk_bf16_f32 v109, v66, v67
v_cvt_pk_bf16_f32 v110, v72, v73
v_cvt_pk_bf16_f32 v111, v74, v75
v_pk_fma_f32 v[136:137], v[68:69], s[40:41], s[40:41] neg_lo:[0,0,1] neg_hi:[0,0,1]
v_pk_fma_f32 v[138:139], v[70:71], s[40:41], s[40:41] neg_lo:[0,0,1] neg_hi:[0,0,1]
v_pk_fma_f32 v[140:141], v[76:77], s[40:41], s[40:41] neg_lo:[0,0,1] neg_hi:[0,0,1]
v_pk_fma_f32 v[142:143], v[78:79], s[40:41], s[40:41] neg_lo:[0,0,1] neg_hi:[0,0,1]
v_exp_f32_e64 v136, v136 clamp
v_exp_f32_e64 v137, v137 clamp
v_exp_f32_e64 v138, v138 clamp
v_exp_f32_e64 v139, v139 clamp
v_exp_f32_e64 v140, v140 clamp
v_exp_f32_e64 v141, v141 clamp
v_exp_f32_e64 v142, v142 clamp
v_exp_f32_e64 v143, v143 clamp
v_max_f32 v68, v68, v136
v_max_f32 v69, v69, v137
v_max_f32 v70, v70, v138
v_max_f32 v71, v71, v139
v_max_f32 v76, v76, v140
v_max_f32 v77, v77, v141
v_max_f32 v78, v78, v142
v_max_f32 v79, v79, v143
v_pk_add_f32 v[68:69], v[68:69], s[42:43]
v_pk_add_f32 v[70:71], v[70:71], s[42:43]
v_pk_add_f32 v[76:77], v[76:77], s[42:43]
v_pk_add_f32 v[78:79], v[78:79], s[42:43]
v_cvt_pk_bf16_f32 v128, v68, v69
v_cvt_pk_bf16_f32 v129, v70, v71
v_cvt_pk_bf16_f32 v130, v76, v77
v_cvt_pk_bf16_f32 v131, v78, v79
v_pk_fma_f32 v[136:137], v[80:81], s[40:41], s[40:41] neg_lo:[0,0,1] neg_hi:[0,0,1]
v_pk_fma_f32 v[138:139], v[82:83], s[40:41], s[40:41] neg_lo:[0,0,1] neg_hi:[0,0,1]
v_pk_fma_f32 v[140:141], v[88:89], s[40:41], s[40:41] neg_lo:[0,0,1] neg_hi:[0,0,1]
v_pk_fma_f32 v[142:143], v[90:91], s[40:41], s[40:41] neg_lo:[0,0,1] neg_hi:[0,0,1]
v_exp_f32_e64 v136, v136 clamp
v_exp_f32_e64 v137, v137 clamp
v_exp_f32_e64 v138, v138 clamp
v_exp_f32_e64 v139, v139 clamp
v_exp_f32_e64 v140, v140 clamp
v_exp_f32_e64 v141, v141 clamp
v_exp_f32_e64 v142, v142 clamp
v_exp_f32_e64 v143, v143 clamp
v_max_f32 v80, v80, v136
v_max_f32 v81, v81, v137
v_max_f32 v82, v82, v138
v_max_f32 v83, v83, v139
v_max_f32 v88, v88, v140
v_max_f32 v89, v89, v141
v_max_f32 v90, v90, v142
v_max_f32 v91, v91, v143
v_pk_add_f32 v[80:81], v[80:81], s[42:43]
v_pk_add_f32 v[82:83], v[82:83], s[42:43]
v_pk_add_f32 v[88:89], v[88:89], s[42:43]
v_pk_add_f32 v[90:91], v[90:91], s[42:43]
v_cvt_pk_bf16_f32 v112, v80, v81
v_cvt_pk_bf16_f32 v113, v82, v83
v_cvt_pk_bf16_f32 v114, v88, v89
v_cvt_pk_bf16_f32 v115, v90, v91
v_pk_fma_f32 v[136:137], v[84:85], s[40:41], s[40:41] neg_lo:[0,0,1] neg_hi:[0,0,1]
v_pk_fma_f32 v[138:139], v[86:87], s[40:41], s[40:41] neg_lo:[0,0,1] neg_hi:[0,0,1]
v_pk_fma_f32 v[140:141], v[92:93], s[40:41], s[40:41] neg_lo:[0,0,1] neg_hi:[0,0,1]
v_pk_fma_f32 v[142:143], v[94:95], s[40:41], s[40:41] neg_lo:[0,0,1] neg_hi:[0,0,1]
v_exp_f32_e64 v136, v136 clamp
v_exp_f32_e64 v137, v137 clamp
v_exp_f32_e64 v138, v138 clamp
v_exp_f32_e64 v139, v139 clamp
v_exp_f32_e64 v140, v140 clamp
v_exp_f32_e64 v141, v141 clamp
v_exp_f32_e64 v142, v142 clamp
v_exp_f32_e64 v143, v143 clamp
v_max_f32 v84, v84, v136
v_max_f32 v85, v85, v137
v_max_f32 v86, v86, v138
v_max_f32 v87, v87, v139
v_max_f32 v92, v92, v140
v_max_f32 v93, v93, v141
v_max_f32 v94, v94, v142
v_max_f32 v95, v95, v143
v_pk_add_f32 v[84:85], v[84:85], s[42:43]
v_pk_add_f32 v[86:87], v[86:87], s[42:43]
v_pk_add_f32 v[92:93], v[92:93], s[42:43]
v_pk_add_f32 v[94:95], v[94:95], s[42:43]
v_cvt_pk_bf16_f32 v132, v84, v85
v_cvt_pk_bf16_f32 v133, v86, v87
v_cvt_pk_bf16_f32 v134, v92, v93
v_cvt_pk_bf16_f32 v135, v94, v95
s_cmp_lg_u32 s22, 0
s_nop 0
s_cbranch_scc1 k1_qp20
s_mov_b32 s52, 0
k1_tk22:
s_waitcnt vmcnt(0)
v_readfirstlane_b32 s50, v156
v_readfirstlane_b32 s51, v157
s_add_u32 s52, s52, 1
s_xor_b32 s53, s50, s51
s_cmp_eq_u32 s53, -1
s_nop 1
s_cbranch_scc1 k1_tk23
buffer_load_dwordx2 v[156:157], off, s[64:67], 0 sc1
s_cmp_lt_u32 s52, 32768
s_cbranch_scc1 k1_tk22
k1_tk23:
s_waitcnt lgkmcnt(0)
s_mov_b32 s52, 0
k1_pl24:
buffer_load_dwordx2 v[248:249], v158, s[16:19], s45 offen sc1
s_add_u32 s52, s52, 1
s_waitcnt vmcnt(0)
v_cmp_ne_u64 vcc, s[50:51], v[248:249]
s_nop 4
s_cbranch_vccz k1_pl25
s_sleep 1
s_cmp_lt_u32 s52, 32768
s_cbranch_scc1 k1_pl24
k1_pl25:
v_mov_b32 v156, 1
ds_write_b32 v159, v156 offset:8
s_nop 0
s_branch k1_qp21
k1_qp20:
s_waitcnt vmcnt(0)
s_mov_b32 s52, 0
k1_lw26:
ds_read_b32 v156, v159 offset:8
s_add_u32 s52, s52, 1
s_waitcnt lgkmcnt(0)
v_readfirstlane_b32 s53, v156
s_cmp_ge_u32 s53, 1
s_nop 3
s_cbranch_scc1 k1_lw27
s_sleep 1
s_cmp_lt_u32 s52, 524288
s_cbranch_scc1 k1_lw26
k1_lw27:
k1_qp21:
buffer_load_dword v12, v10, s[16:19], s24 offen offset:0 sc1
buffer_load_dword v13, v10, s[16:19], s25 offen offset:0 sc1
buffer_load_dword v6, v10, s[16:19], s24 offen offset:128 sc1
buffer_load_dword v7, v10, s[16:19], s25 offen offset:128 sc1
s_waitcnt lgkmcnt(0)
buffer_load_dwordx4 v[160:163], v8, s[16:19], s27 offen sc1
s_add_u32 s27, s27, 5120
buffer_load_dwordx4 v[164:167], v8, s[16:19], s27 offen sc1
s_add_u32 s27, s27, 5120
buffer_load_dwordx4 v[168:171], v8, s[16:19], s27 offen sc1
s_add_u32 s27, s27, 5120
buffer_load_dwordx4 v[172:175], v8, s[16:19], s27 offen sc1
s_add_u32 s27, s27, 5120
buffer_load_dwordx4 v[176:179], v8, s[16:19], s27 offen sc1
s_add_u32 s27, s27, 5120
buffer_load_dwordx4 v[180:183], v8, s[16:19], s27 offen sc1
s_add_u32 s27, s27, 5120
buffer_load_dwordx4 v[184:187], v8, s[16:19], s27 offen sc1
s_add_u32 s27, s27, 5120
buffer_load_dwordx4 v[188:191], v8, s[16:19], s27 offen sc1
s_add_u32 s27, s27, 5120
buffer_load_dwordx4 v[192:195], v8, s[16:19], s27 offen sc1
s_add_u32 s27, s27, 5120
buffer_load_dwordx4 v[196:199], v8, s[16:19], s27 offen sc1
s_add_u32 s27, s27, 5120
buffer_load_dwordx4 v[200:203], v8, s[16:19], s27 offen sc1
s_add_u32 s27, s27, 5120
buffer_load_dwordx4 v[204:207], v8, s[16:19], s27 offen sc1
s_add_u32 s27, s27, 5120
buffer_load_dwordx4 v[208:211], v8, s[16:19], s27 offen sc1
s_add_u32 s27, s27, 5120
buffer_load_dwordx4 v[212:215], v8, s[16:19], s27 offen sc1
s_add_u32 s27, s27, 5120
buffer_load_dwordx4 v[216:219], v8, s[16:19], s27 offen sc1
s_add_u32 s27, s27, 5120
buffer_load_dwordx4 v[220:223], v8, s[16:19], s27 offen sc1
s_waitcnt vmcnt(16)
v_add_f32 v12, v12, v13
v_add_f32 v6, v6, v7
v_cvt_pk_bf16_f32 v12, v12, v12
v_cvt_pk_bf16_f32 v6, v6, v6
v_lshlrev_b32 v12, 16, v12
v_lshlrev_b32 v6, 16, v6
v_mul_f32 v12, 0xbfb8aa3b, v12
v_mul_f32 v6, 0xbfb8aa3b, v6
v_exp_f32 v12, v12
v_exp_f32 v6, v6
v_add_f32 v12, 1.0, v12
v_add_f32 v6, 1.0, v6
v_rcp_f32 v12, v12
v_rcp_f32 v6, v6
v_cvt_pk_bf16_f32 v12, v12, v12
v_cvt_pk_bf16_f32 v6, v6, v6
v_lshlrev_b32 v12, 16, v12
v_lshlrev_b32 v6, 16, v6
v_sub_f32 v13, 1.0, v12
v_sub_f32 v7, 1.0, v6
v_cvt_pk_bf16_f32 v13, v13, v13
v_cvt_pk_bf16_f32 v7, v7, v7
v_lshlrev_b32 v13, 16, v13
v_lshlrev_b32 v7, 16, v7
v_max_f32 v13, 0x21800000, v13
v_max_f32 v7, 0x21800000, v7
v_mul_f32 v13, 0x35cccccd, v13
v_mul_f32 v7, 0x35cccccd, v7
v_rcp_f32 v14, v13
v_rcp_f32 v15, v7
v_mul_f32 v12, v12, v14
v_mul_f32 v6, v6, v15
s_waitcnt vmcnt(14)
v_pk_add_f32 v[160:161], v[160:161], v[164:165]
v_pk_add_f32 v[162:163], v[162:163], v[166:167]
s_waitcnt vmcnt(12)
v_pk_add_f32 v[168:169], v[168:169], v[172:173]
v_pk_add_f32 v[170:171], v[170:171], v[174:175]
v_pk_add_f32 v[160:161], v[160:161], v[168:169]
v_pk_add_f32 v[162:163], v[162:163], v[170:171]
s_waitcnt vmcnt(10)
v_pk_add_f32 v[176:177], v[176:177], v[180:181]
v_pk_add_f32 v[178:179], v[178:179], v[182:183]
s_waitcnt vmcnt(8)
v_pk_add_f32 v[184:185], v[184:185], v[188:189]
v_pk_add_f32 v[186:187], v[186:187], v[190:191]
v_pk_add_f32 v[176:177], v[176:177], v[184:185]
v_pk_add_f32 v[178:179], v[178:179], v[186:187]
v_pk_add_f32 v[160:161], v[160:161], v[176:177]
v_pk_add_f32 v[162:163], v[162:163], v[178:179]
s_waitcnt vmcnt(6)
v_pk_add_f32 v[192:193], v[192:193], v[196:197]
v_pk_add_f32 v[194:195], v[194:195], v[198:199]
s_waitcnt vmcnt(4)
v_pk_add_f32 v[200:201], v[200:201], v[204:205]
v_pk_add_f32 v[202:203], v[202:203], v[206:207]
v_pk_add_f32 v[192:193], v[192:193], v[200:201]
v_pk_add_f32 v[194:195], v[194:195], v[202:203]
s_waitcnt vmcnt(2)
v_pk_add_f32 v[208:209], v[208:209], v[212:213]
v_pk_add_f32 v[210:211], v[210:211], v[214:215]
s_waitcnt vmcnt(0)
v_pk_add_f32 v[216:217], v[216:217], v[220:221]
v_pk_add_f32 v[218:219], v[218:219], v[222:223]
v_pk_add_f32 v[208:209], v[208:209], v[216:217]
v_pk_add_f32 v[210:211], v[210:211], v[218:219]
v_pk_add_f32 v[192:193], v[192:193], v[208:209]
v_pk_add_f32 v[194:195], v[194:195], v[210:211]
v_pk_add_f32 v[160:161], v[160:161], v[192:193]
v_pk_add_f32 v[162:163], v[162:163], v[194:195]
v_cvt_pk_bf16_f32 v160, v160, v161
v_cvt_pk_bf16_f32 v161, v162, v163
ds_write_b64 v9, v[160:161]
ds_read_b64 v[224:225], v144 offset:0
ds_read_b64 v[226:227], v145 offset:40
ds_read_b64 v[228:229], v144 offset:160
ds_read_b64 v[230:231], v145 offset:200
ds_read_b64 v[232:233], v146 offset:80
ds_read_b64 v[234:235], v147 offset:120
ds_read_b64 v[236:237], v146 offset:240
ds_read_b64 v[238:239], v147 offset:280
ds_read_b64 v[240:241], v148
ds_read_b64 v[242:243], v149
ds_read_b64 v[244:245], v150
ds_read_b64 v[246:247], v151
s_cmp_lg_u32 s21, 0
s_cbranch_scc1 k1_qs28
s_mov_b64 exec, 0xffff
buffer_store_dword v13, v10, s[16:19], s26 offen offset:0 sc1
buffer_store_dword v7, v10, s[16:19], s26 offen offset:64 sc1
s_mov_b64 exec, -1
s_nop 0
k1_qs28:
s_waitcnt lgkmcnt(10)
v_mfma_f32_16x16x32_bf16 v[164:167], v[224:227], v[96:99], v[152:155]
v_mfma_f32_16x16x32_bf16 v[176:179], v[224:227], v[116:119], v[152:155]
s_waitcnt lgkmcnt(8)
v_mfma_f32_16x16x32_bf16 v[168:171], v[228:231], v[104:107], v[152:155]
v_mfma_f32_16x16x32_bf16 v[180:183], v[228:231], v[124:127], v[152:155]
s_waitcnt lgkmcnt(6)
v_mfma_f32_16x16x32_bf16 v[164:167], v[232:235], v[100:103], v[164:167]
v_mfma_f32_16x16x32_bf16 v[176:179], v[232:235], v[120:123], v[176:179]
s_waitcnt lgkmcnt(4)
v_mfma_f32_16x16x32_bf16 v[168:171], v[236:239], v[108:111], v[168:171]
v_mfma_f32_16x16x32_bf16 v[180:183], v[236:239], v[128:131], v[180:183]
s_waitcnt lgkmcnt(2)
v_mfma_f32_16x16x32_bf16 v[164:167], v[240:243], v[112:115], v[164:167]
v_mfma_f32_16x16x32_bf16 v[176:179], v[240:243], v[132:135], v[176:179]
s_waitcnt lgkmcnt(0)
v_mfma_f32_16x16x32_bf16 v[168:171], v[244:247], v[112:115], v[168:171]
v_mfma_f32_16x16x32_bf16 v[180:183], v[244:247], v[132:135], v[180:183]
s_nop 3
v_rcp_f32 v164, v164
v_rcp_f32 v165, v165
v_rcp_f32 v166, v166
v_rcp_f32 v167, v167
v_rcp_f32 v168, v168
v_rcp_f32 v169, v169
v_rcp_f32 v170, v170
v_rcp_f32 v171, v171
v_mul_f32 v188, v164, v12
v_mul_f32 v190, v165, v12
v_mul_f32 v192, v166, v12
v_mul_f32 v194, v167, v12
v_mul_f32 v196, v168, v12
v_mul_f32 v198, v169, v12
v_mul_f32 v200, v170, v12
v_mul_f32 v202, v171, v12
v_cndmask_b32 v172, v188, v194, s[54:55]
v_cndmask_b32 v173, v198, v200, s[54:55]
v_cndmask_b32 v174, v190, v192, s[54:55]
v_cndmask_b32 v175, v196, v202, s[54:55]
v_pk_mul_f32 v[16:17], v[16:17], v[188:189] op_sel:[0,0] op_sel_hi:[1,0]
v_pk_mul_f32 v[18:19], v[18:19], v[188:189] op_sel:[0,0] op_sel_hi:[1,0]
v_pk_mul_f32 v[24:25], v[24:25], v[190:191] op_sel:[0,0] op_sel_hi:[1,0]
v_pk_mul_f32 v[26:27], v[26:27], v[190:191] op_sel:[0,0] op_sel_hi:[1,0]
v_cvt_pk_bf16_f32 v96, v16, v17
v_cvt_pk_bf16_f32 v97, v18, v19
v_cvt_pk_bf16_f32 v98, v24, v25
v_cvt_pk_bf16_f32 v99, v26, v27
buffer_store_dwordx4 v[96:99], v11, s[16:19], s38 offen offset:0 sc1
v_cndmask_b32 v172, v172, v173, s[58:59]
v_cndmask_b32 v174, v174, v175, s[58:59]
v_pk_mul_f32 v[32:33], v[32:33], v[192:193] op_sel:[0,0] op_sel_hi:[1,0]
v_pk_mul_f32 v[34:35], v[34:35], v[192:193] op_sel:[0,0] op_sel_hi:[1,0]
v_pk_mul_f32 v[40:41], v[40:41], v[194:195] op_sel:[0,0] op_sel_hi:[1,0]
v_pk_mul_f32 v[42:43], v[42:43], v[194:195] op_sel:[0,0] op_sel_hi:[1,0]
v_cvt_pk_bf16_f32 v100, v32, v33
v_cvt_pk_bf16_f32 v101, v34, v35
v_cvt_pk_bf16_f32 v102, v40, v41
v_cvt_pk_bf16_f32 v103, v42, v43
buffer_store_dwordx4 v[100:103], v11, s[16:19], s38 offen offset:1024 sc1
v_pk_mul_f32 v[48:49], v[48:49], v[196:197] op_sel:[0,0] op_sel_hi:[1,0]
v_pk_mul_f32 v[50:51], v[50:51], v[196:197] op_sel:[0,0] op_sel_hi:[1,0]
v_pk_mul_f32 v[56:57], v[56:57], v[198:199] op_sel:[0,0] op_sel_hi:[1,0]
v_pk_mul_f32 v[58:59], v[58:59], v[198:199] op_sel:[0,0] op_sel_hi:[1,0]
v_cvt_pk_bf16_f32 v104, v48, v49
v_cvt_pk_bf16_f32 v105, v50, v51
v_cvt_pk_bf16_f32 v106, v56, v57
v_cvt_pk_bf16_f32 v107, v58, v59
buffer_store_dwordx4 v[104:107], v11, s[16:19], s38 offen offset:2048 sc1
v_pk_mul_f32 v[64:65], v[64:65], v[200:201] op_sel:[0,0] op_sel_hi:[1,0]
v_pk_mul_f32 v[66:67], v[66:67], v[200:201] op_sel:[0,0] op_sel_hi:[1,0]
v_pk_mul_f32 v[72:73], v[72:73], v[202:203] op_sel:[0,0] op_sel_hi:[1,0]
v_pk_mul_f32 v[74:75], v[74:75], v[202:203] op_sel:[0,0] op_sel_hi:[1,0]
v_cvt_pk_bf16_f32 v108, v64, v65
v_cvt_pk_bf16_f32 v109, v66, v67
v_cvt_pk_bf16_f32 v110, v72, v73
v_cvt_pk_bf16_f32 v111, v74, v75
buffer_store_dwordx4 v[108:111], v11, s[16:19], s38 offen offset:3072 sc1
v_pk_mul_f32 v[80:81], v[80:81], v[172:173] op_sel:[0,0] op_sel_hi:[1,0]
v_pk_mul_f32 v[82:83], v[82:83], v[172:173] op_sel:[0,0] op_sel_hi:[1,0]
v_pk_mul_f32 v[88:89], v[88:89], v[174:175] op_sel:[0,0] op_sel_hi:[1,0]
v_pk_mul_f32 v[90:91], v[90:91], v[174:175] op_sel:[0,0] op_sel_hi:[1,0]
v_cvt_pk_bf16_f32 v112, v80, v81
v_cvt_pk_bf16_f32 v113, v82, v83
v_cvt_pk_bf16_f32 v114, v88, v89
v_cvt_pk_bf16_f32 v115, v90, v91
buffer_store_dwordx4 v[112:115], v5, s[16:19], s38 offen sc1
v_rcp_f32 v176, v176
v_rcp_f32 v177, v177
v_rcp_f32 v178, v178
v_rcp_f32 v179, v179
v_rcp_f32 v180, v180
v_rcp_f32 v181, v181
v_rcp_f32 v182, v182
v_rcp_f32 v183, v183
v_mul_f32 v206, v176, v6
v_mul_f32 v208, v177, v6
v_mul_f32 v210, v178, v6
v_mul_f32 v212, v179, v6
v_mul_f32 v214, v180, v6
v_mul_f32 v216, v181, v6
v_mul_f32 v218, v182, v6
v_mul_f32 v220, v183, v6
v_cndmask_b32 v184, v206, v212, s[54:55]
v_cndmask_b32 v185, v216, v218, s[54:55]
v_cndmask_b32 v186, v208, v210, s[54:55]
v_cndmask_b32 v187, v214, v220, s[54:55]
v_pk_mul_f32 v[20:21], v[20:21], v[206:207] op_sel:[0,0] op_sel_hi:[1,0]
v_pk_mul_f32 v[22:23], v[22:23], v[206:207] op_sel:[0,0] op_sel_hi:[1,0]
v_pk_mul_f32 v[28:29], v[28:29], v[208:209] op_sel:[0,0] op_sel_hi:[1,0]
v_pk_mul_f32 v[30:31], v[30:31], v[208:209] op_sel:[0,0] op_sel_hi:[1,0]
v_cvt_pk_bf16_f32 v116, v20, v21
v_cvt_pk_bf16_f32 v117, v22, v23
v_cvt_pk_bf16_f32 v118, v28, v29
v_cvt_pk_bf16_f32 v119, v30, v31
buffer_store_dwordx4 v[116:119], v11, s[16:19], s39 offen offset:0 sc1
v_cndmask_b32 v184, v184, v185, s[58:59]
v_cndmask_b32 v186, v186, v187, s[58:59]
v_pk_mul_f32 v[36:37], v[36:37], v[210:211] op_sel:[0,0] op_sel_hi:[1,0]
v_pk_mul_f32 v[38:39], v[38:39], v[210:211] op_sel:[0,0] op_sel_hi:[1,0]
v_pk_mul_f32 v[44:45], v[44:45], v[212:213] op_sel:[0,0] op_sel_hi:[1,0]
v_pk_mul_f32 v[46:47], v[46:47], v[212:213] op_sel:[0,0] op_sel_hi:[1,0]
v_cvt_pk_bf16_f32 v120, v36, v37
v_cvt_pk_bf16_f32 v121, v38, v39
v_cvt_pk_bf16_f32 v122, v44, v45
v_cvt_pk_bf16_f32 v123, v46, v47
buffer_store_dwordx4 v[120:123], v11, s[16:19], s39 offen offset:1024 sc1
v_pk_mul_f32 v[52:53], v[52:53], v[214:215] op_sel:[0,0] op_sel_hi:[1,0]
v_pk_mul_f32 v[54:55], v[54:55], v[214:215] op_sel:[0,0] op_sel_hi:[1,0]
v_pk_mul_f32 v[60:61], v[60:61], v[216:217] op_sel:[0,0] op_sel_hi:[1,0]
v_pk_mul_f32 v[62:63], v[62:63], v[216:217] op_sel:[0,0] op_sel_hi:[1,0]
v_cvt_pk_bf16_f32 v124, v52, v53
v_cvt_pk_bf16_f32 v125, v54, v55
v_cvt_pk_bf16_f32 v126, v60, v61
v_cvt_pk_bf16_f32 v127, v62, v63
buffer_store_dwordx4 v[124:127], v11, s[16:19], s39 offen offset:2048 sc1
v_pk_mul_f32 v[68:69], v[68:69], v[218:219] op_sel:[0,0] op_sel_hi:[1,0]
v_pk_mul_f32 v[70:71], v[70:71], v[218:219] op_sel:[0,0] op_sel_hi:[1,0]
v_pk_mul_f32 v[76:77], v[76:77], v[220:221] op_sel:[0,0] op_sel_hi:[1,0]
v_pk_mul_f32 v[78:79], v[78:79], v[220:221] op_sel:[0,0] op_sel_hi:[1,0]
v_cvt_pk_bf16_f32 v128, v68, v69
v_cvt_pk_bf16_f32 v129, v70, v71
v_cvt_pk_bf16_f32 v130, v76, v77
v_cvt_pk_bf16_f32 v131, v78, v79
buffer_store_dwordx4 v[128:131], v11, s[16:19], s39 offen offset:3072 sc1
v_pk_mul_f32 v[84:85], v[84:85], v[184:185] op_sel:[0,0] op_sel_hi:[1,0]
v_pk_mul_f32 v[86:87], v[86:87], v[184:185] op_sel:[0,0] op_sel_hi:[1,0]
v_pk_mul_f32 v[92:93], v[92:93], v[186:187] op_sel:[0,0] op_sel_hi:[1,0]
v_pk_mul_f32 v[94:95], v[94:95], v[186:187] op_sel:[0,0] op_sel_hi:[1,0]
v_cvt_pk_bf16_f32 v132, v84, v85
v_cvt_pk_bf16_f32 v133, v86, v87
v_cvt_pk_bf16_f32 v134, v92, v93
v_cvt_pk_bf16_f32 v135, v94, v95
buffer_store_dwordx4 v[132:135], v5, s[16:19], s39 offen sc1
s_endpgm
k1_f:
s_mov_b32 s45, s46
s_mov_b32 s52, 3
s_branch k1_fgen
k1_f2:
s_and_b32 s38, s21, 1
s_lshl_b32 s38, s38, 6
s_lshr_b32 s39, s21, 1
s_lshl_b32 s40, s39, 11
s_or_b32 s40, s40, s38
v_xor_b32 v104, s40, v6
v_xor_b32 v105, 64, v104
v_xor_b32 v106, 2048, v104
v_xor_b32 v107, 2048, v105
v_lshl_add_u32 v12, v2, 4, s38
s_lshl_b32 s46, s46, 7
s_mov_b32 s58, 1280
s_mov_b32 s59, 0x00020000
s_waitcnt lgkmcnt(0)
buffer_load_dwordx4 v[96:99], v12, s[56:59], s46 offen
s_lshl_b32 s39, s39, 10
s_add_u32 s39, s39, s29
v_lshlrev_b32 v15, 8, v2
v_add_u32 v15, s39, v15
v_cvt_f32_u32 v15, v15
v_mul_f32 v15, 0x3a000000, v15
v_add_u32 v13, 0, v3
v_cvt_f32_u32 v13, v13
v_mul_f32 v14, v13, v15
v_mov_b32 v16, v14
v_fmamk_f32 v17, v13, 0x3d000000, v14
v_fmamk_f32 v18, v13, 0x3d800000, v14
v_fmamk_f32 v19, v13, 0x3dc00000, v14
v_fmamk_f32 v20, v13, 0x3f000000, v14
v_fmamk_f32 v21, v13, 0x3f080000, v14
v_fmamk_f32 v22, v13, 0x3f100000, v14
v_fmamk_f32 v23, v13, 0x3f180000, v14
v_cos_f32 v24, v16
v_sin_f32 v32, v16
v_cos_f32 v25, v17
v_sin_f32 v33, v17
v_cos_f32 v26, v18
v_sin_f32 v34, v18
v_cos_f32 v27, v19
v_sin_f32 v35, v19
v_cos_f32 v28, v20
v_sin_f32 v36, v20
v_cos_f32 v29, v21
v_sin_f32 v37, v21
v_cos_f32 v30, v22
v_sin_f32 v38, v22
v_cos_f32 v31, v23
v_sin_f32 v39, v23
v_cvt_pk_bf16_f32 v136, v24, v25
v_cvt_pk_bf16_f32 v140, v32, v33
v_cvt_pk_bf16_f32 v144, -v32, -v33
v_cvt_pk_bf16_f32 v137, v26, v27
v_cvt_pk_bf16_f32 v141, v34, v35
v_cvt_pk_bf16_f32 v145, -v34, -v35
v_cvt_pk_bf16_f32 v138, v28, v29
v_cvt_pk_bf16_f32 v142, v36, v37
v_cvt_pk_bf16_f32 v146, -v36, -v37
v_cvt_pk_bf16_f32 v139, v30, v31
v_cvt_pk_bf16_f32 v143, v38, v39
v_cvt_pk_bf16_f32 v147, -v38, -v39
v_add_u32 v13, 16, v3
v_cvt_f32_u32 v13, v13
v_mul_f32 v14, v13, v15
v_mov_b32 v16, v14
v_fmamk_f32 v17, v13, 0x3d000000, v14
v_fmamk_f32 v18, v13, 0x3d800000, v14
v_fmamk_f32 v19, v13, 0x3dc00000, v14
v_fmamk_f32 v20, v13, 0x3f000000, v14
v_fmamk_f32 v21, v13, 0x3f080000, v14
v_fmamk_f32 v22, v13, 0x3f100000, v14
v_fmamk_f32 v23, v13, 0x3f180000, v14
v_cos_f32 v24, v16
v_sin_f32 v32, v16
v_cos_f32 v25, v17
v_sin_f32 v33, v17
v_cos_f32 v26, v18
v_sin_f32 v34, v18
v_cos_f32 v27, v19
v_sin_f32 v35, v19
v_cos_f32 v28, v20
v_sin_f32 v36, v20
v_cos_f32 v29, v21
v_sin_f32 v37, v21
v_cos_f32 v30, v22
v_sin_f32 v38, v22
v_cos_f32 v31, v23
v_sin_f32 v39, v23
v_cvt_pk_bf16_f32 v148, v24, v25
v_cvt_pk_bf16_f32 v152, v32, v33
v_cvt_pk_bf16_f32 v156, -v32, -v33
v_cvt_pk_bf16_f32 v149, v26, v27
v_cvt_pk_bf16_f32 v153, v34, v35
v_cvt_pk_bf16_f32 v157, -v34, -v35
v_cvt_pk_bf16_f32 v150, v28, v29
v_cvt_pk_bf16_f32 v154, v36, v37
v_cvt_pk_bf16_f32 v158, -v36, -v37
v_cvt_pk_bf16_f32 v151, v30, v31
v_cvt_pk_bf16_f32 v155, v38, v39
v_cvt_pk_bf16_f32 v159, -v38, -v39
v_mov_b32 v16, 0
v_mov_b32 v17, 0
v_mov_b32 v18, 0
v_mov_b32 v19, 0
v_mov_b32 v20, 0
v_mov_b32 v21, 0
v_mov_b32 v22, 0
v_mov_b32 v23, 0
v_mov_b32 v24, 0
v_mov_b32 v25, 0
v_mov_b32 v26, 0
v_mov_b32 v27, 0
v_mov_b32 v28, 0
v_mov_b32 v29, 0
v_mov_b32 v30, 0
v_mov_b32 v31, 0
v_mov_b32 v32, 0
v_mov_b32 v33, 0
v_mov_b32 v34, 0
v_mov_b32 v35, 0
v_mov_b32 v36, 0
v_mov_b32 v37, 0
v_mov_b32 v38, 0
v_mov_b32 v39, 0
v_mov_b32 v40, 0
v_mov_b32 v41, 0
v_mov_b32 v42, 0
v_mov_b32 v43, 0
v_mov_b32 v44, 0
v_mov_b32 v45, 0
v_mov_b32 v46, 0
v_mov_b32 v47, 0
v_mov_b32 v48, 0
v_mov_b32 v49, 0
v_mov_b32 v50, 0
v_mov_b32 v51, 0
v_mov_b32 v52, 0
v_mov_b32 v53, 0
v_mov_b32 v54, 0
v_mov_b32 v55, 0
v_mov_b32 v56, 0
v_mov_b32 v57, 0
v_mov_b32 v58, 0
v_mov_b32 v59, 0
v_mov_b32 v60, 0
v_mov_b32 v61, 0
v_mov_b32 v62, 0
v_mov_b32 v63, 0
v_mov_b32 v64, 0
v_mov_b32 v65, 0
v_mov_b32 v66, 0
v_mov_b32 v67, 0
v_mov_b32 v68, 0
v_mov_b32 v69, 0
v_mov_b32 v70, 0
v_mov_b32 v71, 0
v_mov_b32 v72, 0
v_mov_b32 v73, 0
v_mov_b32 v74, 0
v_mov_b32 v75, 0
v_mov_b32 v76, 0
v_mov_b32 v77, 0
v_mov_b32 v78, 0
v_mov_b32 v79, 0
v_mov_b32 v80, 0
v_mov_b32 v81, 0
v_mov_b32 v82, 0
v_mov_b32 v83, 0
v_mov_b32 v84, 0
v_mov_b32 v85, 0
v_mov_b32 v86, 0
v_mov_b32 v87, 0
v_mov_b32 v88, 0
v_mov_b32 v89, 0
v_mov_b32 v90, 0
v_mov_b32 v91, 0
v_mov_b32 v92, 0
v_mov_b32 v93, 0
v_mov_b32 v94, 0
v_mov_b32 v95, 0
v_mov_b32 v100, 0
v_mov_b32 v101, 0
v_mov_b32 v102, 0
v_mov_b32 v103, 0
v_and_b32 v15, 1, v3
v_lshlrev_b32 v15, 31, v15
v_mov_b32 v4, v104
v_mov_b32 v5, v105
v_mov_b32 v6, v106
v_mov_b32 v7, v107
v_mov_b32 v13, v11
s_mov_b32 s50, 0
s_mov_b32 s51, 0
s_mov_b32 s45, 0
s_waitcnt lgkmcnt(0)
s_barrier
ds_read_b128 v[160:163], v4
ds_read_b128 v[176:179], v13 offset:0
ds_read_b128 v[164:167], v6
ds_read_b128 v[180:183], v13 offset:1024
ds_read_b128 v[184:187], v13 offset:2048
ds_read_b128 v[188:191], v13 offset:3072
ds_read_b128 v[192:195], v13 offset:4096
ds_read_b128 v[196:199], v13 offset:5120
ds_read_b128 v[200:203], v13 offset:6144
ds_read_b128 v[204:207], v13 offset:7168
ds_read_b128 v[208:211], v13 offset:8192
ds_read_b128 v[212:215], v13 offset:9216
k1_floop:
s_waitcnt lgkmcnt(5)
v_mfma_f32_16x16x32_bf16 v[16:19], v[160:163], v[176:179], v[16:19]
ds_read_b128 v[168:171], v5
ds_read_b128 v[216:219], v13 offset:10240
v_mfma_f32_16x16x32_bf16 v[20:23], v[164:167], v[176:179], v[20:23]
ds_read_b128 v[172:175], v7
ds_read_b128 v[220:223], v13 offset:11264
v_mfma_f32_16x16x32_bf16 v[24:27], v[160:163], v[180:183], v[24:27]
ds_read_b128 v[224:227], v13 offset:12288
v_mfma_f32_16x16x32_bf16 v[28:31], v[164:167], v[180:183], v[28:31]
ds_read_b128 v[228:231], v13 offset:13312
v_mfma_f32_16x16x32_bf16 v[32:35], v[160:163], v[184:187], v[32:35]
ds_read_b128 v[232:235], v13 offset:14336
v_mfma_f32_16x16x32_bf16 v[36:39], v[164:167], v[184:187], v[36:39]
ds_read_b128 v[236:239], v13 offset:15360
v_mfma_f32_16x16x32_bf16 v[40:43], v[160:163], v[188:191], v[40:43]
ds_read_b128 v[240:243], v13 offset:16384
v_mfma_f32_16x16x32_bf16 v[44:47], v[164:167], v[188:191], v[44:47]
ds_read_b128 v[244:247], v13 offset:17408
v_mfma_f32_16x16x32_bf16 v[48:51], v[160:163], v[192:195], v[48:51]
ds_read_b128 v[248:251], v13 offset:18432
v_mfma_f32_16x16x32_bf16 v[52:55], v[164:167], v[192:195], v[52:55]
ds_read_b128 v[252:255], v13 offset:19456
s_waitcnt lgkmcnt(12)
v_mfma_f32_16x16x32_bf16 v[56:59], v[160:163], v[196:199], v[56:59]
s_add_u32 s50, s50, 20480
s_cmp_eq_u32 s50, 102400
s_cselect_b32 s50, 0, s50
v_mfma_f32_16x16x32_bf16 v[60:63], v[164:167], v[196:199], v[60:63]
s_add_u32 s51, s51, 16384
s_cmp_eq_u32 s51, 49152
s_cselect_b32 s51, 0, s51
v_mfma_f32_16x16x32_bf16 v[64:67], v[160:163], v[200:203], v[64:67]
s_add_u32 s46, s46, 128
s_cmp_eq_u32 s46, 1280
s_cselect_b32 s46, 0, s46
v_mfma_f32_16x16x32_bf16 v[68:71], v[164:167], v[200:203], v[68:71]
v_mfma_f32_16x16x32_bf16 v[72:75], v[160:163], v[204:207], v[72:75]
s_waitcnt vmcnt(0)
v_mfma_f32_16x16x32_bf16 v[100:103], v[160:163], v[96:99], v[100:103]
v_mfma_f32_16x16x32_bf16 v[76:79], v[164:167], v[204:207], v[76:79]
v_mfma_f32_16x16x32_bf16 v[80:83], v[160:163], v[208:211], v[80:83]
buffer_load_dwordx4 v[96:99], v12, s[56:59], s46 offen
v_mfma_f32_16x16x32_bf16 v[84:87], v[164:167], v[208:211], v[84:87]
v_mfma_f32_16x16x32_bf16 v[88:91], v[160:163], v[212:215], v[88:91]
v_mfma_f32_16x16x32_bf16 v[92:95], v[164:167], v[212:215], v[92:95]
s_waitcnt lgkmcnt(5)
v_mfma_f32_16x16x32_bf16 v[16:19], v[168:171], v[216:219], v[16:19]
v_add_u32 v4, s51, v104
v_add_u32 v5, s51, v105
v_mfma_f32_16x16x32_bf16 v[20:23], v[172:175], v[216:219], v[20:23]
v_add_u32 v6, s51, v106
v_add_u32 v7, s51, v107
v_mfma_f32_16x16x32_bf16 v[24:27], v[168:171], v[220:223], v[24:27]
v_add_u32 v13, s50, v11
s_sub_u32 s44, s44, 1
v_mfma_f32_16x16x32_bf16 v[28:31], v[172:175], v[220:223], v[28:31]
s_cmp_lg_u32 s44, 0
s_waitcnt lgkmcnt(0)
s_barrier
v_mfma_f32_16x16x32_bf16 v[32:35], v[168:171], v[224:227], v[32:35]
ds_read_b128 v[160:163], v4
v_mfma_f32_16x16x32_bf16 v[36:39], v[172:175], v[224:227], v[36:39]
ds_read_b128 v[176:179], v13 offset:0
v_mfma_f32_16x16x32_bf16 v[40:43], v[168:171], v[228:231], v[40:43]
ds_read_b128 v[164:167], v6
v_mfma_f32_16x16x32_bf16 v[44:47], v[172:175], v[228:231], v[44:47]
ds_read_b128 v[180:183], v13 offset:1024
v_mfma_f32_16x16x32_bf16 v[48:51], v[168:171], v[232:235], v[48:51]
ds_read_b128 v[184:187], v13 offset:2048
v_mfma_f32_16x16x32_bf16 v[52:55], v[172:175], v[232:235], v[52:55]
ds_read_b128 v[188:191], v13 offset:3072
v_mfma_f32_16x16x32_bf16 v[56:59], v[168:171], v[236:239], v[56:59]
ds_read_b128 v[192:195], v13 offset:4096
v_mfma_f32_16x16x32_bf16 v[60:63], v[172:175], v[236:239], v[60:63]
ds_read_b128 v[196:199], v13 offset:5120
v_mfma_f32_16x16x32_bf16 v[64:67], v[168:171], v[240:243], v[64:67]
ds_read_b128 v[200:203], v13 offset:6144
v_mfma_f32_16x16x32_bf16 v[68:71], v[172:175], v[240:243], v[68:71]
ds_read_b128 v[204:207], v13 offset:7168
v_mfma_f32_16x16x32_bf16 v[72:75], v[168:171], v[244:247], v[72:75]
ds_read_b128 v[208:211], v13 offset:8192
v_mfma_f32_16x16x32_bf16 v[76:79], v[172:175], v[244:247], v[76:79]
ds_read_b128 v[212:215], v13 offset:9216
v_mfma_f32_16x16x32_bf16 v[80:83], v[168:171], v[248:251], v[80:83]
v_mfma_f32_16x16x32_bf16 v[84:87], v[172:175], v[248:251], v[84:87]
v_mfma_f32_16x16x32_bf16 v[88:91], v[168:171], v[252:255], v[88:91]
v_mfma_f32_16x16x32_bf16 v[92:95], v[172:175], v[252:255], v[92:95]
s_cbranch_scc1 k1_floop
s_cmp_lg_u32 s45, 0
s_cbranch_scc1 k1_fdone
v_xor_b32 v16, v15, v16
v_xor_b32 v17, v15, v17
v_xor_b32 v18, v15, v18
v_xor_b32 v19, v15, v19
v_xor_b32 v20, v15, v20
v_xor_b32 v21, v15, v21
v_xor_b32 v22, v15, v22
v_xor_b32 v23, v15, v23
v_xor_b32 v24, v15, v24
v_xor_b32 v25, v15, v25
v_xor_b32 v26, v15, v26
v_xor_b32 v27, v15, v27
v_xor_b32 v28, v15, v28
v_xor_b32 v29, v15, v29
v_xor_b32 v30, v15, v30
v_xor_b32 v31, v15, v31
v_xor_b32 v32, v15, v32
v_xor_b32 v33, v15, v33
v_xor_b32 v34, v15, v34
v_xor_b32 v35, v15, v35
v_xor_b32 v36, v15, v36
v_xor_b32 v37, v15, v37
v_xor_b32 v38, v15, v38
v_xor_b32 v39, v15, v39
v_xor_b32 v40, v15, v40
v_xor_b32 v41, v15, v41
v_xor_b32 v42, v15, v42
v_xor_b32 v43, v15, v43
v_xor_b32 v44, v15, v44
v_xor_b32 v45, v15, v45
v_xor_b32 v46, v15, v46
v_xor_b32 v47, v15, v47
v_xor_b32 v48, v15, v48
v_xor_b32 v49, v15, v49
v_xor_b32 v50, v15, v50
v_xor_b32 v51, v15, v51
v_xor_b32 v52, v15, v52
v_xor_b32 v53, v15, v53
v_xor_b32 v54, v15, v54
v_xor_b32 v55, v15, v55
v_xor_b32 v56, v15, v56
v_xor_b32 v57, v15, v57
v_xor_b32 v58, v15, v58
v_xor_b32 v59, v15, v59
v_xor_b32 v60, v15, v60
v_xor_b32 v61, v15, v61
v_xor_b32 v62, v15, v62
v_xor_b32 v63, v15, v63
v_xor_b32 v64, v15, v64
v_xor_b32 v65, v15, v65
v_xor_b32 v66, v15, v66
v_xor_b32 v67, v15, v67
v_xor_b32 v68, v15, v68
v_xor_b32 v69, v15, v69
v_xor_b32 v70, v15, v70
v_xor_b32 v71, v15, v71
v_xor_b32 v72, v15, v72
v_xor_b32 v73, v15, v73
v_xor_b32 v74, v15, v74
v_xor_b32 v75, v15, v75
v_xor_b32 v76, v15, v76
v_xor_b32 v77, v15, v77
v_xor_b32 v78, v15, v78
v_xor_b32 v79, v15, v79
v_xor_b32 v80, v15, v80
v_xor_b32 v81, v15, v81
v_xor_b32 v82, v15, v82
v_xor_b32 v83, v15, v83
v_xor_b32 v84, v15, v84
v_xor_b32 v85, v15, v85
v_xor_b32 v86, v15, v86
v_xor_b32 v87, v15, v87
v_xor_b32 v88, v15, v88
v_xor_b32 v89, v15, v89
v_xor_b32 v90, v15, v90
v_xor_b32 v91, v15, v91
v_xor_b32 v92, v15, v92
v_xor_b32 v93, v15, v93
v_xor_b32 v94, v15, v94
v_xor_b32 v95, v15, v95
s_mov_b32 s45, 1
s_mov_b32 s44, 5
s_branch k1_floop
k1_fdone:
s_and_b32 s38, s21, 1
s_lshl_b32 s38, s38, 7
s_lshl_b32 s39, s29, 1
s_add_u32 s38, s38, s39
s_lshr_b32 s39, s21, 1
s_add_u32 s38, s38, s39
s_lshl_b32 s38, s38, 7
s_add_u32 s38, s38, 12156928
v_and_b32 v12, 1, v3
v_lshlrev_b32 v12, 6, v12
v_lshl_add_u32 v12, v2, 4, v12
buffer_store_dwordx4 v[100:103], v12, s[16:19], s38 offen sc1
buffer_load_dwordx2 v[8:9], off, s[64:67], 0 sc1
s_waitcnt vmcnt(2)
v_lshl_add_u32 v14, v2, 2, s22
v_xor_b32 v14, v14, v3
v_lshlrev_b32 v14, 4, v14
v_lshl_add_u32 v14, v2, 8, v14
s_lshl_b32 s39, s22, 10
s_add_u32 s38, s39, 16384
v_add_u32 v14, s38, v14
v_bfe_u32 v10, v1, 2, 2
v_and_b32 v15, 3, v1
v_lshl_add_u32 v13, v15, 2, v10
s_lshl_b32 s38, s22, 2
v_add_u32 v12, s38, v2
v_xor_b32 v13, v13, v12
v_lshlrev_b32 v13, 4, v13
v_lshl_add_u32 v13, v15, 8, v13
v_lshl_add_u32 v13, v10, 10, v13
v_add_u32 v13, 16384, v13
v_lshlrev_b32 v10, 6, v10
v_lshl_add_u32 v10, v15, 3, v10
v_lshl_add_u32 v10, v2, 5, v10
v_mul_u32_u24 v12, 81920, v2
v_lshl_add_u32 v12, v3, 4, v12
s_add_u32 s39, s39, 58368
v_add_u32 v15, s39, v11
s_mul_i32 s38, s21, 20480
s_mul_i32 s39, s22, 327680
s_add_u32 s38, s38, s39
s_lshl_b32 s39, s20, 8
s_add_u32 s38, s38, s39
s_add_u32 s38, s38, 2621440
s_cmp_eq_u32 s21, 0
s_cselect_b32 s44, 0x00010001, 0
s_mov_b32 s45, s44
s_waitcnt lgkmcnt(0)
v_mov_b32 v160, 0
v_mov_b32 v161, 0
v_mov_b32 v162, 0
v_mov_b32 v163, 0
ds_write_b128 v15, v[160:163]
v_cvt_pk_bf16_f32 v108, v40, v41
v_cvt_pk_bf16_f32 v109, v42, v43
v_cvt_pk_bf16_f32 v110, v44, v45
v_cvt_pk_bf16_f32 v111, v46, v47
v_cvt_pk_bf16_f32 v112, v48, v49
v_cvt_pk_bf16_f32 v113, v50, v51
v_cvt_pk_bf16_f32 v114, v52, v53
v_cvt_pk_bf16_f32 v115, v54, v55
v_cvt_pk_bf16_f32 v116, v56, v57
v_cvt_pk_bf16_f32 v117, v58, v59
v_cvt_pk_bf16_f32 v118, v60, v61
v_cvt_pk_bf16_f32 v119, v62, v63
v_cvt_pk_bf16_f32 v120, v64, v65
v_cvt_pk_bf16_f32 v121, v66, v67
v_cvt_pk_bf16_f32 v122, v68, v69
v_cvt_pk_bf16_f32 v123, v70, v71
v_cvt_pk_bf16_f32 v124, v72, v73
v_cvt_pk_bf16_f32 v125, v74, v75
v_cvt_pk_bf16_f32 v126, v76, v77
v_cvt_pk_bf16_f32 v127, v78, v79
v_cvt_pk_bf16_f32 v128, v80, v81
v_cvt_pk_bf16_f32 v129, v82, v83
v_cvt_pk_bf16_f32 v130, v84, v85
v_cvt_pk_bf16_f32 v131, v86, v87
v_cvt_pk_bf16_f32 v132, v88, v89
v_cvt_pk_bf16_f32 v133, v90, v91
v_cvt_pk_bf16_f32 v134, v92, v93
v_cvt_pk_bf16_f32 v135, v94, v95
v_cvt_pk_bf16_f32 v96, v16, v17
v_cvt_pk_bf16_f32 v97, v18, v19
v_cvt_pk_bf16_f32 v98, v20, v21
v_cvt_pk_bf16_f32 v99, v22, v23
v_cvt_pk_bf16_f32 v100, v24, v25
v_cvt_pk_bf16_f32 v101, v26, v27
v_cvt_pk_bf16_f32 v102, v28, v29
v_cvt_pk_bf16_f32 v103, v30, v31
v_cndmask_b32 v4, v100, 0, s[44:45]
v_cndmask_b32 v5, v101, 0, s[44:45]
v_cndmask_b32 v6, v102, 0, s[44:45]
v_cndmask_b32 v7, v103, 0, s[44:45]
v_cvt_pk_bf16_f32 v104, v32, v33
v_cvt_pk_bf16_f32 v105, v34, v35
v_cvt_pk_bf16_f32 v106, v36, v37
v_cvt_pk_bf16_f32 v107, v38, v39
s_nop 1
v_mfma_f32_16x16x32_bf16 v[32:35], v[104:107], v[136:139], 0
v_mfma_f32_16x16x32_bf16 v[40:43], v[108:111], v[136:139], 0
v_mfma_f32_16x16x32_bf16 v[36:39], v[104:107], v[148:151], 0
v_mfma_f32_16x16x32_bf16 v[44:47], v[108:111], v[148:151], 0
v_mfma_f32_16x16x32_bf16 v[32:35], v[108:111], v[140:143], v[32:35]
v_mfma_f32_16x16x32_bf16 v[40:43], v[104:107], v[144:147], v[40:43]
v_mfma_f32_16x16x32_bf16 v[36:39], v[108:111], v[152:155], v[36:39]
v_mfma_f32_16x16x32_bf16 v[44:47], v[104:107], v[156:159], v[44:47]
v_mfma_f32_16x16x32_bf16 v[48:51], v[112:115], v[136:139], 0
v_mfma_f32_16x16x32_bf16 v[56:59], v[116:119], v[136:139], 0
v_mfma_f32_16x16x32_bf16 v[52:55], v[112:115], v[148:151], 0
s_nop 1
v_cvt_pk_bf16_f32 v32, v32, -v33
v_cvt_pk_bf16_f32 v33, v34, -v35
v_mfma_f32_16x16x32_bf16 v[60:63], v[116:119], v[148:151], 0
v_cvt_pk_bf16_f32 v34, v40, -v41
v_cvt_pk_bf16_f32 v35, v42, -v43
v_mfma_f32_16x16x32_bf16 v[48:51], v[116:119], v[140:143], v[48:51]
ds_write_b128 v14, v[32:35] offset:8192
v_cvt_pk_bf16_f32 v36, v36, -v37
v_mfma_f32_16x16x32_bf16 v[56:59], v[112:115], v[144:147], v[56:59]
v_cvt_pk_bf16_f32 v37, v38, -v39
v_cvt_pk_bf16_f32 v38, v44, -v45
v_mfma_f32_16x16x32_bf16 v[52:55], v[116:119], v[152:155], v[52:55]
v_cvt_pk_bf16_f32 v39, v46, -v47
ds_write_b128 v14, v[36:39] offset:12288
v_mfma_f32_16x16x32_bf16 v[60:63], v[112:115], v[156:159], v[60:63]
v_mfma_f32_16x16x32_bf16 v[64:67], v[120:123], v[136:139], 0
v_mfma_f32_16x16x32_bf16 v[72:75], v[124:127], v[136:139], 0
v_mfma_f32_16x16x32_bf16 v[68:71], v[120:123], v[148:151], 0
v_cvt_pk_bf16_f32 v48, v48, -v49
v_cvt_pk_bf16_f32 v49, v50, -v51
v_mfma_f32_16x16x32_bf16 v[76:79], v[124:127], v[148:151], 0
v_cvt_pk_bf16_f32 v50, v56, -v57
v_cvt_pk_bf16_f32 v51, v58, -v59
v_mfma_f32_16x16x32_bf16 v[64:67], v[124:127], v[140:143], v[64:67]
ds_write_b128 v14, v[48:51] offset:16384
v_cvt_pk_bf16_f32 v52, v52, -v53
v_mfma_f32_16x16x32_bf16 v[72:75], v[120:123], v[144:147], v[72:75]
v_cvt_pk_bf16_f32 v53, v54, -v55
v_cvt_pk_bf16_f32 v54, v60, -v61
v_mfma_f32_16x16x32_bf16 v[68:71], v[124:127], v[152:155], v[68:71]
v_cvt_pk_bf16_f32 v55, v62, -v63
ds_write_b128 v14, v[52:55] offset:20480
v_mfma_f32_16x16x32_bf16 v[76:79], v[120:123], v[156:159], v[76:79]
v_mfma_f32_16x16x32_bf16 v[80:83], v[128:131], v[136:139], 0
v_mfma_f32_16x16x32_bf16 v[88:91], v[132:135], v[136:139], 0
v_mfma_f32_16x16x32_bf16 v[84:87], v[128:131], v[148:151], 0
v_cvt_pk_bf16_f32 v64, v64, -v65
v_cvt_pk_bf16_f32 v65, v66, -v67
v_cvt_pk_bf16_f32 v66, v72, -v73
v_mfma_f32_16x16x32_bf16 v[92:95], v[132:135], v[148:151], 0
v_cvt_pk_bf16_f32 v67, v74, -v75
ds_write_b128 v14, v[64:67] offset:24576
v_cvt_pk_bf16_f32 v68, v68, -v69
v_mfma_f32_16x16x32_bf16 v[80:83], v[132:135], v[140:143], v[80:83]
v_cvt_pk_bf16_f32 v69, v70, -v71
v_cvt_pk_bf16_f32 v70, v76, -v77
v_cvt_pk_bf16_f32 v71, v78, -v79
v_mfma_f32_16x16x32_bf16 v[88:91], v[128:131], v[144:147], v[88:91]
ds_write_b128 v14, v[68:71] offset:28672
v_mfma_f32_16x16x32_bf16 v[84:87], v[132:135], v[152:155], v[84:87]
v_mfma_f32_16x16x32_bf16 v[92:95], v[128:131], v[156:159], v[92:95]
s_waitcnt lgkmcnt(0)
s_barrier
v_mfma_f32_16x16x32_bf16 v[16:19], v[96:99], v[136:139], 0
ds_read_b64_tr_b16 v[172:173], v13 offset:8192
ds_read_b64_tr_b16 v[174:175], v13 offset:8200
ds_read_b64_tr_b16 v[176:177], v13 offset:12288
v_mfma_f32_16x16x32_bf16 v[24:27], v[4:7], v[136:139], 0
ds_read_b64_tr_b16 v[178:179], v13 offset:12296
ds_read_b64_tr_b16 v[180:181], v13 offset:16384
ds_read_b64_tr_b16 v[182:183], v13 offset:16392
v_mfma_f32_16x16x32_bf16 v[20:23], v[96:99], v[148:151], 0
ds_read_b64_tr_b16 v[184:185], v13 offset:20480
ds_read_b64_tr_b16 v[186:187], v13 offset:20488
ds_read_b64_tr_b16 v[188:189], v13 offset:24576
v_mfma_f32_16x16x32_bf16 v[28:31], v[4:7], v[148:151], 0
ds_read_b64_tr_b16 v[190:191], v13 offset:24584
ds_read_b64_tr_b16 v[192:193], v13 offset:28672
ds_read_b64_tr_b16 v[194:195], v13 offset:28680
v_mfma_f32_16x16x32_bf16 v[16:19], v[4:7], v[140:143], v[16:19]
v_cvt_pk_bf16_f32 v80, v80, -v81
v_cvt_pk_bf16_f32 v81, v82, -v83
v_cvt_pk_bf16_f32 v82, v88, -v89
v_mfma_f32_16x16x32_bf16 v[24:27], v[96:99], v[144:147], v[24:27]
v_cvt_pk_bf16_f32 v83, v90, -v91
ds_write_b128 v14, v[80:83] offset:32768
v_cvt_pk_bf16_f32 v84, v84, -v85
v_mfma_f32_16x16x32_bf16 v[20:23], v[4:7], v[152:155], v[20:23]
v_cvt_pk_bf16_f32 v85, v86, -v87
v_cvt_pk_bf16_f32 v86, v92, -v93
v_cvt_pk_bf16_f32 v87, v94, -v95
v_mfma_f32_16x16x32_bf16 v[28:31], v[96:99], v[156:159], v[28:31]
ds_write_b128 v14, v[84:87] offset:36864
s_cmp_lg_u32 s21, 0
s_nop 5
s_cbranch_scc1 k1_fs29
v_mfma_f32_16x16x32_bf16 v[104:107], v[100:103], v[136:139], 0
v_mfma_f32_16x16x32_bf16 v[108:111], v[100:103], v[148:151], 0
v_mfma_f32_16x16x32_bf16 v[112:115], v[100:103], v[144:147], 0
v_mfma_f32_16x16x32_bf16 v[116:119], v[100:103], v[156:159], 0
s_nop 7
k1_fs29:
s_waitcnt lgkmcnt(12)
s_add_u32 s39, s38, 4096
buffer_store_dwordx4 v[172:175], v12, s[16:19], s39 offen sc1
s_waitcnt lgkmcnt(10)
s_add_u32 s39, s38, 1314816
buffer_store_dwordx4 v[176:179], v12, s[16:19], s39 offen sc1
v_cvt_pk_bf16_f32 v16, v16, -v17
v_cvt_pk_bf16_f32 v17, v18, -v19
v_cvt_pk_bf16_f32 v18, v24, -v25
v_cvt_pk_bf16_f32 v19, v26, -v27
ds_write_b128 v14, v[16:19] offset:0
v_cvt_pk_bf16_f32 v20, v20, -v21
v_cvt_pk_bf16_f32 v21, v22, -v23
v_cvt_pk_bf16_f32 v22, v28, -v29
v_cvt_pk_bf16_f32 v23, v30, -v31
ds_write_b128 v14, v[20:23] offset:4096
s_waitcnt lgkmcnt(10)
s_add_u32 s39, s38, 8192
buffer_store_dwordx4 v[180:183], v12, s[16:19], s39 offen sc1
s_waitcnt lgkmcnt(8)
s_add_u32 s39, s38, 1318912
buffer_store_dwordx4 v[184:187], v12, s[16:19], s39 offen sc1
s_waitcnt lgkmcnt(6)
s_add_u32 s39, s38, 12288
buffer_store_dwordx4 v[188:191], v12, s[16:19], s39 offen sc1
s_waitcnt lgkmcnt(4)
s_add_u32 s39, s38, 1323008
buffer_store_dwordx4 v[192:195], v12, s[16:19], s39 offen sc1
s_cmp_lg_u32 s21, 0
s_nop 0
s_cbranch_scc1 k1_fs30
s_lshl_b32 s39, s22, 6
v_lshl_add_u32 v15, v3, 1, s39
s_mov_b64 exec, 0xffff
v_cvt_pk_bf16_f32 v104, v104, v108
ds_write_b16 v15, v104 offset:57344
ds_write_b16_d16_hi v15, v104 offset:57376
v_cvt_pk_bf16_f32 v112, v112, v116
ds_write_b16 v15, v112 offset:57600
ds_write_b16_d16_hi v15, v112 offset:57632
s_mov_b64 exec, -1
k1_fs30:
s_waitcnt lgkmcnt(0)
s_barrier
ds_read_b64_tr_b16 v[196:197], v13 offset:32768
ds_read_b64_tr_b16 v[198:199], v13 offset:32776
ds_read_b64_tr_b16 v[200:201], v13 offset:36864
ds_read_b64_tr_b16 v[202:203], v13 offset:36872
ds_read_b64_tr_b16 v[164:165], v13 offset:0
ds_read_b64_tr_b16 v[166:167], v13 offset:8
ds_read_b64_tr_b16 v[168:169], v13 offset:4096
ds_read_b64_tr_b16 v[170:171], v13 offset:4104
s_or_b32 s39, s21, s22
s_cmp_lg_u32 s39, 0
s_cbranch_scc1 k1_fs31
ds_read_b64_tr_b16 v[104:105], v10 offset:57344
ds_read_b64_tr_b16 v[106:107], v10 offset:57600
s_lshl_b32 s39, s20, 9
s_add_u32 s39, s39, 12058624
s_waitcnt lgkmcnt(0)
s_mov_b64 exec, 0xffffffff
buffer_store_dwordx4 v[104:107], v11, s[16:19], s39 offen sc1
s_mov_b64 exec, -1
s_nop 0
k1_fs31:
s_waitcnt lgkmcnt(6)
s_add_u32 s39, s38, 16384
buffer_store_dwordx4 v[196:199], v12, s[16:19], s39 offen sc1
s_waitcnt lgkmcnt(4)
s_add_u32 s39, s38, 1327104
buffer_store_dwordx4 v[200:203], v12, s[16:19], s39 offen sc1
s_waitcnt lgkmcnt(2)
s_add_u32 s39, s38, 0
buffer_store_dwordx4 v[164:167], v12, s[16:19], s39 offen sc1
s_waitcnt lgkmcnt(0)
s_add_u32 s39, s38, 1310720
buffer_store_dwordx4 v[168:171], v12, s[16:19], s39 offen sc1
s_lshl_b32 s38, s22, 6
v_add_u32 v12, s38, v1
v_min_u32 v12, 199, v12
v_cmp_le_u32 vcc, 100, v12
s_nop 1
v_cndmask_b32 v13, 0, 1, vcc
v_mul_u32_u24 v14, 100, v13
v_sub_u32 v12, v12, v14
v_mul_u32_u24 v14, 205, v12
v_lshrrev_b32 v14, 12, v14
v_mul_u32_u24 v15, 20, v14
v_sub_u32 v12, v12, v15
v_mul_u32_u24 v36, 21, v13
v_add_u32 v36, v36, v12
v_mul_u32_u24 v36, 80, v36
v_and_b32 v15, 1, v14
v_lshl_add_u32 v36, v15, 4, v36
v_bfe_u32 v15, v14, 1, 1
v_lshl_add_u32 v36, v15, 3, v36
v_lshrrev_b32 v15, 2, v14
v_lshl_add_u32 v36, v15, 5, v36
s_lshr_b32 s38, s34, 2
s_lshl_b32 s39, s38, 1
v_add_u32 v13, s39, v13
v_mad_u32_u24 v12, v13, 20, v12
v_mad_u32_u24 v14, v13, 5, v14
v_lshrrev_b32 v13, 4, v12
v_max_u32 v15, 1, v13
v_lshrrev_b32 v16, 2, v14
v_sub_u32 v15, v16, v15
v_add_u32 v15, 1, v15
v_and_b32 v12, 15, v12
v_lshlrev_b32 v12, 4, v12
v_lshl_add_u32 v12, v13, 11, v12
v_and_b32 v14, 3, v14
v_lshl_add_u32 v12, v14, 8, v12
v_lshrrev_b32 v14, 1, v15
v_lshl_add_u32 v12, v14, 10, v12
v_and_b32 v15, 1, v15
v_lshl_add_u32 v12, v15, 3, v12
v_lshlrev_b32 v13, 2, v3
ds_bpermute_b32 v16, v13, v12 offset:0
ds_bpermute_b32 v17, v13, v12 offset:64
ds_bpermute_b32 v18, v13, v12 offset:128
ds_bpermute_b32 v19, v13, v12 offset:192
v_and_b32 v14, 1, v3
v_lshlrev_b32 v14, 4, v14
s_movk_i32 s39, 0x3f80
v_lshlrev_b32 v14, v14, s39
v_lshrrev_b32 v15, 1, v3
v_cmp_eq_u32 vcc, 0, v15
s_nop 1
v_cndmask_b32 v20, 0, v14, vcc
v_cndmask_b32 v22, 0, v14, vcc
v_cmp_eq_u32 vcc, 1, v15
s_nop 1
v_cndmask_b32 v21, 0, v14, vcc
v_cndmask_b32 v23, 0, v14, vcc
v_cmp_eq_u32 vcc, 2, v15
s_nop 1
v_cndmask_b32 v24, 0, v14, vcc
v_cndmask_b32 v26, 0, v14, vcc
v_cmp_eq_u32 vcc, 3, v15
s_nop 1
v_cndmask_b32 v25, 0, v14, vcc
v_cndmask_b32 v27, 0, v14, vcc
v_cmp_eq_u32 vcc, 4, v15
s_nop 1
v_cndmask_b32 v28, 0, v14, vcc
v_cndmask_b32 v30, 0, v14, vcc
v_cmp_eq_u32 vcc, 5, v15
s_nop 1
v_cndmask_b32 v29, 0, v14, vcc
v_cndmask_b32 v31, 0, v14, vcc
v_cmp_eq_u32 vcc, 6, v15
s_nop 1
v_cndmask_b32 v32, 0, v14, vcc
v_cndmask_b32 v34, 0, v14, vcc
v_cmp_eq_u32 vcc, 7, v15
s_nop 1
v_cndmask_b32 v33, 0, v14, vcc
v_cndmask_b32 v35, 0, v14, vcc
v_mul_u32_u24 v37, 80, v3
v_lshl_add_u32 v37, v2, 4, v37
v_and_b32 v14, 3, v3
v_add_u32 v14, 16, v14
v_lshrrev_b32 v15, 2, v3
v_cmp_eq_u32 vcc, 0, v15
s_nop 1
v_cndmask_b32 v4, 20, v14, vcc
v_mul_u32_u24 v4, 80, v4
v_lshl_add_u32 v4, v2, 4, v4
v_cmp_eq_u32 vcc, 1, v15
s_nop 1
v_cndmask_b32 v5, 20, v14, vcc
v_mul_u32_u24 v5, 80, v5
v_lshl_add_u32 v5, v2, 4, v5
v_cmp_eq_u32 vcc, 2, v15
s_nop 1
v_cndmask_b32 v6, 20, v14, vcc
v_mul_u32_u24 v6, 80, v6
v_lshl_add_u32 v6, v2, 4, v6
s_mul_i32 s39, s22, 5
s_lshr_b32 s39, s39, 1
s_lshl_b32 s39, s39, 5
v_bfe_u32 v12, v1, 2, 2
v_and_b32 v13, 3, v1
v_lshl_add_u32 v13, v13, 3, s39
v_sub_u32 v15, 6, v2
v_cmp_gt_u32 vcc, 2, v2
v_add_u32 v14, 0, v2
s_nop 0
v_cndmask_b32 v14, v15, v14, vcc
v_lshl_add_u32 v14, v14, 2, v12
v_mul_u32_u24 v14, 320, v14
v_add_u32 v38, v13, v14
v_add_u32 v14, 2, v2
v_cndmask_b32 v14, v15, v14, vcc
v_lshl_add_u32 v14, v14, 2, v12
v_mul_u32_u24 v14, 320, v14
v_add_u32 v39, v13, v14
v_mul_u32_u24 v14, 327680, v2
s_waitcnt lgkmcnt(0)
v_add_u32 v16, v16, v14
v_add_u32 v17, v17, v14
v_add_u32 v18, v18, v14
v_add_u32 v19, v19, v14
s_mul_i32 s24, s32, 10240
s_add_u32 s24, s24, 8716288
s_add_u32 s25, s24, 81920
s_add_u32 s26, s24, 163840
s_add_u32 s27, s24, 245760
s_lshl_b32 s39, s32, 1
s_add_u32 s38, s38, s39
s_and_b32 s39, s38, 3
s_lshr_b32 s38, s38, 2
s_mul_i32 s38, s38, 25600
s_and_b32 s40, s34, 3
s_lshl_b32 s40, s40, 1
s_lshr_b32 s41, s22, 1
s_add_u32 s40, s40, s41
s_mul_i32 s40, s40, 102400
s_add_u32 s38, s38, s40
s_and_b32 s41, s22, 1
s_lshl_b32 s41, s41, 11
s_add_u32 s38, s38, s41
s_add_u32 s38, s38, 7864320
s_lshl_b32 s41, s39, 8
s_add_u32 s41, s41, s38
s_add_u32 s41, s41, 20480
s_mul_i32 s40, s39, 5120
s_add_u32 s40, s40, s38
s_add_u32 s39, s39, 1
s_bitcmp1_b32 s39, 1
s_cselect_b64 s[42:43], -1, 0
v_lshlrev_b32 v7, 10, v2
v_lshl_add_u32 v7, v3, 4, v7
v_lshlrev_b32 v10, 7, v3
s_mul_i32 s46, s32, 34816
s_add_u32 s46, s46, 12206080
s_lshl_b32 s45, s21, 11
s_lshl_b32 s44, s20, 7
s_add_u32 s45, s45, s44
s_add_u32 s45, s45, 12197888
v_mov_b32 v12, 151552
v_mov_b32 v13, 1
v_lshrrev_b32 v14, 3, v1
v_and_b32 v152, 7, v1
v_lshlrev_b32 v152, 4, v152
v_lshl_add_u32 v14, v14, 15, v152
s_mov_b32 s52, 0
s_nop 0
k1_tk33:
s_waitcnt vmcnt(0)
v_readfirstlane_b32 s50, v8
v_readfirstlane_b32 s51, v9
s_add_u32 s52, s52, 1
s_xor_b32 s53, s50, s51
s_cmp_eq_u32 s53, -1
s_nop 1
s_cbranch_scc1 k1_tk34
buffer_load_dwordx2 v[8:9], off, s[64:67], 0 sc1
s_cmp_lt_u32 s52, 32768
s_cbranch_scc1 k1_tk33
k1_tk34:
s_mov_b64 exec, 1
ds_add_rtn_u32 v13, v12, v13
s_mov_b64 exec, -1
v_mov_b32 v152, s50
v_mov_b32 v153, s51
v_mov_b32 v154, s50
v_mov_b32 v155, s51
s_waitcnt lgkmcnt(0)
v_readfirstlane_b32 s53, v13
s_cmp_lg_u32 s53, 3
s_nop 3
s_cbranch_scc1 k1_sg32
buffer_store_dwordx4 v[152:155], v14, s[16:19], s45 offen sc1
s_nop 1
k1_sg32:
v_mov_b32 v14, 151552
v_mov_b32 v15, 1
s_cmp_lg_u32 s22, 0
s_nop 0
s_cbranch_scc1 k1_fp35
s_mov_b32 s52, 0
k1_pl37:
buffer_load_dwordx2 v[160:161], v10, s[16:19], s46 offen sc1
s_add_u32 s52, s52, 1
s_waitcnt vmcnt(0)
v_cmp_ne_u64 vcc, s[50:51], v[160:161]
s_nop 4
s_cbranch_vccz k1_pl38
s_sleep 1
s_cmp_lt_u32 s52, 32768
s_cbranch_scc1 k1_pl37
k1_pl38:
ds_write_b32 v14, v15 offset:8
s_branch k1_fp36
k1_fp35:
s_mov_b32 s52, 0
k1_lw39:
ds_read_b32 v12, v14 offset:8
s_add_u32 s52, s52, 1
s_waitcnt lgkmcnt(0)
v_readfirstlane_b32 s53, v12
s_cmp_ge_u32 s53, 1
s_nop 3
s_cbranch_scc1 k1_lw40
s_sleep 1
s_cmp_lt_u32 s52, 524288
s_cbranch_scc1 k1_lw39
k1_lw40:
k1_fp36:
buffer_load_dwordx2 v[40:41], v16, s[16:19], s24 offen sc1
buffer_load_dwordx2 v[42:43], v16, s[16:19], s25 offen sc1
buffer_load_dwordx2 v[44:45], v16, s[16:19], s26 offen sc1
buffer_load_dwordx2 v[46:47], v16, s[16:19], s27 offen sc1
buffer_load_dwordx2 v[48:49], v17, s[16:19], s24 offen sc1
buffer_load_dwordx2 v[50:51], v17, s[16:19], s25 offen sc1
buffer_load_dwordx2 v[52:53], v17, s[16:19], s26 offen sc1
buffer_load_dwordx2 v[54:55], v17, s[16:19], s27 offen sc1
buffer_load_dwordx2 v[56:57], v18, s[16:19], s24 offen sc1
buffer_load_dwordx2 v[58:59], v18, s[16:19], s25 offen sc1
buffer_load_dwordx2 v[60:61], v18, s[16:19], s26 offen sc1
buffer_load_dwordx2 v[62:63], v18, s[16:19], s27 offen sc1
buffer_load_dwordx2 v[64:65], v19, s[16:19], s24 offen sc1
buffer_load_dwordx2 v[66:67], v19, s[16:19], s25 offen sc1
buffer_load_dwordx2 v[68:69], v19, s[16:19], s26 offen sc1
buffer_load_dwordx2 v[70:71], v19, s[16:19], s27 offen sc1
ds_read_b64_tr_b16 v[72:73], v38 offset:0
ds_read_b64_tr_b16 v[74:75], v39 offset:0
ds_read_b64_tr_b16 v[76:77], v38 offset:6400
ds_read_b64_tr_b16 v[78:79], v39 offset:6400
ds_read_b64_tr_b16 v[80:81], v38 offset:32
ds_read_b64_tr_b16 v[82:83], v39 offset:32
ds_read_b64_tr_b16 v[84:85], v38 offset:6432
ds_read_b64_tr_b16 v[86:87], v39 offset:6432
ds_read_b64_tr_b16 v[88:89], v38 offset:64
ds_read_b64_tr_b16 v[90:91], v39 offset:64
ds_read_b64_tr_b16 v[92:93], v38 offset:6464
ds_read_b64_tr_b16 v[94:95], v39 offset:6464
s_waitcnt vmcnt(14)
v_mfma_f32_16x16x32_bf16 v[128:131], v[20:23], v[40:43], 0
s_waitcnt vmcnt(12)
v_mfma_f32_16x16x32_bf16 v[128:131], v[20:23], v[44:47], v[128:131]
s_waitcnt vmcnt(10)
v_mfma_f32_16x16x32_bf16 v[128:131], v[24:27], v[48:51], v[128:131]
s_waitcnt vmcnt(8)
v_mfma_f32_16x16x32_bf16 v[128:131], v[24:27], v[52:55], v[128:131]
s_waitcnt vmcnt(6)
v_mfma_f32_16x16x32_bf16 v[128:131], v[28:31], v[56:59], v[128:131]
s_waitcnt vmcnt(4)
v_mfma_f32_16x16x32_bf16 v[128:131], v[28:31], v[60:63], v[128:131]
s_waitcnt vmcnt(2)
v_mfma_f32_16x16x32_bf16 v[128:131], v[32:35], v[64:67], v[128:131]
s_waitcnt vmcnt(0)
v_mfma_f32_16x16x32_bf16 v[128:131], v[32:35], v[68:71], v[128:131]
s_nop 7
v_cvt_pk_bf16_f32 v128, v128, v129
v_cvt_pk_bf16_f32 v129, v130, v131
ds_write_b64 v36, v[128:129] offset:58368
s_mov_b64 exec, 1
ds_add_u32 v14, v15 offset:16
s_mov_b64 exec, -1
s_mov_b32 s52, 0
k1_lw41:
ds_read_b32 v12, v14 offset:16
s_add_u32 s52, s52, 1
s_waitcnt lgkmcnt(0)
v_readfirstlane_b32 s53, v12
s_cmp_ge_u32 s53, 4
s_nop 3
s_cbranch_scc1 k1_lw42
s_cmp_lt_u32 s52, 524288
s_cbranch_scc1 k1_lw41
k1_lw42:
ds_read_b128 v[96:99], v37 offset:58368
ds_read_b128 v[100:103], v37 offset:60048
ds_read_b128 v[104:107], v4 offset:58368
ds_read_b128 v[108:111], v4 offset:60048
ds_read_b128 v[112:115], v5 offset:58368
ds_read_b128 v[116:119], v5 offset:60048
ds_read_b128 v[120:123], v6 offset:58368
ds_read_b128 v[124:127], v6 offset:60048
s_waitcnt lgkmcnt(6)
v_mfma_f32_16x16x32_bf16 v[136:139], v[96:99], v[72:75], 0
v_mfma_f32_16x16x32_bf16 v[140:143], v[100:103], v[76:79], 0
v_mfma_f32_16x16x32_bf16 v[144:147], v[96:99], v[80:83], 0
v_mfma_f32_16x16x32_bf16 v[148:151], v[100:103], v[84:87], 0
v_mfma_f32_16x16x32_bf16 v[152:155], v[96:99], v[88:91], 0
v_mfma_f32_16x16x32_bf16 v[156:159], v[100:103], v[92:95], 0
s_waitcnt lgkmcnt(4)
v_mfma_f32_16x16x32_bf16 v[128:131], v[104:107], v[72:75], 0
v_mfma_f32_16x16x32_bf16 v[132:135], v[108:111], v[76:79], 0
v_cvt_pk_bf16_f32 v136, v136, v137
v_cvt_pk_bf16_f32 v137, v138, v139
v_cvt_pk_bf16_f32 v138, v140, v141
v_cvt_pk_bf16_f32 v139, v142, v143
buffer_store_dwordx4 v[136:139], v11, s[16:19], s40 offen offset:0 sc1
s_waitcnt lgkmcnt(2)
v_mfma_f32_16x16x32_bf16 v[128:131], v[112:115], v[80:83], v[128:131]
v_mfma_f32_16x16x32_bf16 v[132:135], v[116:119], v[84:87], v[132:135]
v_cvt_pk_bf16_f32 v144, v144, v145
v_cvt_pk_bf16_f32 v145, v146, v147
v_cvt_pk_bf16_f32 v146, v148, v149
v_cvt_pk_bf16_f32 v147, v150, v151
buffer_store_dwordx4 v[144:147], v11, s[16:19], s40 offen offset:1024 sc1
s_waitcnt lgkmcnt(0)
v_mfma_f32_16x16x32_bf16 v[128:131], v[120:123], v[88:91], v[128:131]
v_mfma_f32_16x16x32_bf16 v[132:135], v[124:127], v[92:95], v[132:135]
v_cvt_pk_bf16_f32 v152, v152, v153
v_cvt_pk_bf16_f32 v153, v154, v155
v_cvt_pk_bf16_f32 v154, v156, v157
v_cvt_pk_bf16_f32 v155, v158, v159
buffer_store_dwordx4 v[152:155], v11, s[16:19], s40 offen offset:2048 sc1
s_nop 1
v_cvt_pk_bf16_f32 v128, v128, v129
v_cvt_pk_bf16_f32 v129, v130, v131
v_cvt_pk_bf16_f32 v130, v132, v133
v_cvt_pk_bf16_f32 v131, v134, v135
v_cndmask_b32 v132, v128, v130, s[42:43]
v_cndmask_b32 v133, v129, v131, s[42:43]
v_cndmask_b32 v134, v130, v128, s[42:43]
v_cndmask_b32 v135, v131, v129, s[42:43]
s_mov_b32 exec_hi, 0xffff
buffer_store_dwordx4 v[132:135], v7, s[16:19], s41 offen sc1
s_nop 1
k1_end:
s_endpgm
.globl k3_kernel
.p2align 8
.type k3_kernel,@function
k3_kernel:
s_cmp_ge_u32 s2, 256
s_cbranch_scc1 k3_end
s_load_dwordx2 s[16:17], s[0:1], 72
s_load_dwordx2 s[20:21], s[0:1], 56
v_lshrrev_b32 v8, 6, v0
v_and_b32 v1, 63, v0
v_readfirstlane_b32 s32, v8
v_lshlrev_b32 v4, 4, v1
s_and_b32 s36, s2, 7
s_lshr_b32 s37, s2, 3
s_lshr_b32 s33, s36, 1
s_lshl_b32 s33, s33, 3
s_and_b32 s38, s37, 7
s_add_u32 s33, s33, s38
s_and_b32 s34, s36, 1
s_lshl_b32 s34, s34, 2
s_lshr_b32 s38, s37, 3
s_add_u32 s34, s34, s38
s_xor_b32 s35, s32, 3
s_mov_b32 s18, 12468224
s_mov_b32 s19, 0x00020000
v_and_b32 v3, 15, v1
v_lshrrev_b32 v2, 4, v1
v_add_u32 v5, 4096, v4
v_add_u32 v6, 8192, v4
s_lshl_b32 s36, s33, 2
s_mul_i32 s37, s32, 5120
s_lshr_b32 s39, s35, 1
s_lshl_b32 s57, s37, 1
s_lshl_b32 s56, s33, 1
s_and_b32 s55, s35, 1
s_lshl_b32 s55, s55, 10
s_xor_b32 s38, s39, 0
s_add_u32 s58, s38, s56
s_mul_i32 s38, s58, 40960
s_add_u32 s38, s38, s57
s_add_u32 s50, s38, 5242880
s_add_u32 s58, s58, s55
s_xor_b32 s38, s39, 1
s_add_u32 s59, s38, s56
s_mul_i32 s38, s59, 40960
s_add_u32 s38, s38, s57
s_add_u32 s51, s38, 5242880
s_add_u32 s59, s59, s55
s_mul_i32 s66, s32, 21504
s_add_u32 s66, s66, 61440
s_lshl_b32 s67, s33, 10
s_add_u32 s67, s67, 12124160
s_xor_b32 s38, s35, 0
s_add_u32 s38, s38, s36
s_mul_i32 s38, s38, 20480
s_add_u32 s40, s38, s37
s_xor_b32 s38, s35, 1
s_add_u32 s38, s38, s36
s_mul_i32 s38, s38, 20480
s_add_u32 s41, s38, s37
s_xor_b32 s38, s35, 2
s_add_u32 s38, s38, s36
s_mul_i32 s38, s38, 20480
s_add_u32 s42, s38, s37
s_xor_b32 s38, s35, 3
s_add_u32 s38, s38, s36
s_lshl_b32 s52, s38, 6
s_add_u32 s52, s52, 12091392
s_mul_i32 s38, s38, 20480
s_add_u32 s43, s38, s37
s_mul_i32 s38, s34, 102400
s_mul_i32 s39, s32, 25600
s_add_u32 s38, s38, s39
s_add_u32 s44, s38, 7864320
s_add_u32 s45, s38, 7869440
s_add_u32 s46, s38, 7874560
s_add_u32 s47, s38, 7879680
s_add_u32 s48, s38, 7884800
s_cmp_eq_u32 s32, 0
s_cselect_b32 s60, 0xffff, 0
s_mov_b32 s61, 0
s_cselect_b32 s64, 0x00010001, 0
s_mov_b32 s65, s64
v_cvt_f32_u32 v13, v2
v_mul_f32 v13, 4.0, v13
v_lshl_add_u32 v204, v3, 6, s58
v_cvt_f32_u32 v204, v204
v_mul_f32 v204, 0x3a000000, v204
v_mul_f32 v196, v13, v204
v_cos_f32 v205, v204
v_add_f32 v197, v196, v204
v_fmamk_f32 v200, v204, 0x41800000, v196
v_add_f32 v205, v205, v205
v_add_f32 v201, v200, v204
v_cos_f32 v188, v196
v_sin_f32 v196, v196
v_cos_f32 v189, v197
v_sin_f32 v197, v197
v_cos_f32 v192, v200
v_sin_f32 v200, v200
v_cos_f32 v193, v201
v_sin_f32 v201, v201
v_fma_f32 v190, v205, v189, -v188
v_fma_f32 v198, v205, v197, -v196
v_fma_f32 v194, v205, v193, -v192
v_fma_f32 v202, v205, v201, -v200
v_fma_f32 v191, v205, v190, -v189
v_fma_f32 v199, v205, v198, -v197
v_fma_f32 v195, v205, v194, -v193
v_fma_f32 v203, v205, v202, -v201
v_cvt_pk_bf16_f32 v40, v188, v189
v_cvt_pk_bf16_f32 v44, v196, v197
v_cvt_pk_bf16_f32 v48, -v196, -v197
v_cvt_pk_bf16_f32 v41, v190, v191
v_cvt_pk_bf16_f32 v45, v198, v199
v_cvt_pk_bf16_f32 v49, -v198, -v199
v_cvt_pk_bf16_f32 v42, v192, v193
v_cvt_pk_bf16_f32 v46, v200, v201
v_cvt_pk_bf16_f32 v50, -v200, -v201
v_cvt_pk_bf16_f32 v43, v194, v195
v_cvt_pk_bf16_f32 v47, v202, v203
v_cvt_pk_bf16_f32 v51, -v202, -v203
v_xor_b32 v52, 0x80000000, v40
v_xor_b32 v53, 0x80000000, v41
v_xor_b32 v54, 0x80000000, v42
v_xor_b32 v55, 0x80000000, v43
v_xor_b32 v56, 0x80000000, v44
v_xor_b32 v57, 0x80000000, v45
v_xor_b32 v58, 0x80000000, v46
v_xor_b32 v59, 0x80000000, v47
v_xor_b32 v60, 0x80000000, v48
v_xor_b32 v61, 0x80000000, v49
v_xor_b32 v62, 0x80000000, v50
v_xor_b32 v63, 0x80000000, v51
v_lshl_add_u32 v224, v3, 6, s59
v_cvt_f32_u32 v224, v224
v_mul_f32 v224, 0x3a000000, v224
v_mul_f32 v216, v13, v224
v_cos_f32 v225, v224
v_add_f32 v217, v216, v224
v_fmamk_f32 v220, v224, 0x41800000, v216
v_add_f32 v225, v225, v225
v_add_f32 v221, v220, v224
s_waitcnt lgkmcnt(0)
s_add_u32 m0, s66, 0
s_nop 0
buffer_load_dwordx4 v4, s[16:19], s50 offen offset:0 lds
v_cos_f32 v208, v216
v_sin_f32 v216, v216
v_cos_f32 v209, v217
v_sin_f32 v217, v217
buffer_load_dwordx4 v4, s[16:19], s50 offen offset:1024 lds
v_cos_f32 v212, v220
v_sin_f32 v220, v220
v_cos_f32 v213, v221
v_sin_f32 v221, v221
s_add_u32 m0, s66, 10240
s_nop 0
buffer_load_dwordx4 v4, s[16:19], s51 offen offset:0 lds
v_fma_f32 v210, v225, v209, -v208
v_fma_f32 v218, v225, v217, -v216
v_fma_f32 v214, v225, v213, -v212
v_fma_f32 v222, v225, v221, -v220
v_fma_f32 v211, v225, v210, -v209
v_fma_f32 v219, v225, v218, -v217
v_fma_f32 v215, v225, v214, -v213
buffer_load_dwordx4 v4, s[16:19], s51 offen offset:1024 lds
v_fma_f32 v223, v225, v222, -v221
v_cvt_pk_bf16_f32 v64, v208, v209
v_cvt_pk_bf16_f32 v68, v216, v217
v_cvt_pk_bf16_f32 v72, -v216, -v217
v_cvt_pk_bf16_f32 v65, v210, v211
v_cvt_pk_bf16_f32 v69, v218, v219
v_cvt_pk_bf16_f32 v73, -v218, -v219
s_add_u32 m0, s66, 20480
s_nop 0
buffer_load_dwordx4 v4, s[16:19], s67 offen lds
v_cvt_pk_bf16_f32 v66, v212, v213
v_cvt_pk_bf16_f32 v70, v220, v221
v_cvt_pk_bf16_f32 v74, -v220, -v221
v_cvt_pk_bf16_f32 v67, v214, v215
v_cvt_pk_bf16_f32 v71, v222, v223
v_cvt_pk_bf16_f32 v75, -v222, -v223
s_add_u32 m0, s66, 0
s_nop 0
buffer_load_dwordx4 v4, s[16:19], s50 offen offset:2048 lds
v_xor_b32 v76, 0x80000000, v64
v_xor_b32 v77, 0x80000000, v65
v_xor_b32 v78, 0x80000000, v66
v_xor_b32 v79, 0x80000000, v67
v_xor_b32 v80, 0x80000000, v68
v_xor_b32 v81, 0x80000000, v69
v_xor_b32 v82, 0x80000000, v70
buffer_load_dwordx4 v4, s[16:19], s50 offen offset:3072 lds
v_xor_b32 v83, 0x80000000, v71
v_xor_b32 v84, 0x80000000, v72
v_xor_b32 v85, 0x80000000, v73
v_xor_b32 v86, 0x80000000, v74
v_xor_b32 v87, 0x80000000, v75
v_bfe_u32 v12, v1, 2, 2
v_lshl_add_u32 v12, v2, 2, v12
s_add_u32 m0, s66, 10240
s_nop 0
buffer_load_dwordx4 v4, s[16:19], s51 offen offset:2048 lds
v_and_b32 v13, 3, v1
v_lshl_add_u32 v8, v12, 6, s66
v_lshl_add_u32 v8, v13, 4, v8
v_lshl_add_u32 v0, v12, 4, s66
s_mul_i32 s38, s34, 80
v_add_u32 v10, s38, v3
s_mul_i32 s38, s32, 80
buffer_load_dwordx4 v4, s[16:19], s51 offen offset:3072 lds
v_lshl_add_u32 v11, v2, 2, s38
s_mov_b32 s62, 0xc4200000
v_mul_u32_u24 v244, v10, v11
v_cvt_f32_u32 v246, v10
v_cvt_f32_u32 v244, v244
v_cvt_f32_u32 v247, v11
v_mul_f32 v245, 0x3acccccd, v244
v_mul_f32 v248, 0x3acccccd, v246
buffer_load_dwordx4 a[60:63], v4, s[16:19], s40 offen offset:0
v_rndne_f32 v245, v245
v_mul_f32 v247, 0x3ccccccd, v247
v_fma_f32 v244, v245, s62, v244
v_mul_f32 v246, 0x3ccccccd, v246
v_mul_f32 v129, 0x3acccccd, v244
v_fract_f32 v247, v247
v_fract_f32 v246, v246
buffer_load_dwordx4 a[64:67], v4, s[16:19], s44 offen offset:0
v_add_f32 v249, 0x3ccccccd, v248
v_add_f32 v250, 0x3ecccccd, v246
v_add_f32 v131, v129, v248
v_add_f32 v133, v129, v247
v_cos_f32 v173, v248
v_cos_f32 v174, v249
buffer_load_dwordx4 a[68:71], v4, s[16:19], s41 offen offset:0
v_add_f32 v135, v133, v249
v_add_f32 v149, v129, v246
v_add_f32 v151, v131, v246
v_add_f32 v153, v133, v250
v_add_f32 v155, v135, v250
v_cos_f32 v168, v246
buffer_load_dwordx4 a[72:75], v4, s[16:19], s42 offen offset:0
v_cos_f32 v169, v250
v_add_f32 v252, 0x3ccccccd, v247
v_add_f32 v253, 0x3ecccccd, v247
v_add_f32 v254, 0x3ed9999a, v247
v_cos_f32 v251, v247
v_cos_f32 v252, v252
v_cos_f32 v253, v253
v_cos_f32 v254, v254
v_add_f32 v173, v173, v173
v_add_f32 v174, v174, v174
v_add_f32 v168, v168, v168
v_add_f32 v169, v169, v169
v_add_f32 v251, v251, v251
v_add_f32 v252, v252, v252
buffer_load_dwordx4 a[76:79], v4, s[16:19], s44 offen offset:1024
v_add_f32 v253, v253, v253
v_add_f32 v254, v254, v254
v_cos_f32 v128, v129
v_sin_f32_e64 v129, -v129
v_cos_f32 v130, v131
v_sin_f32_e64 v131, -v131
v_cos_f32 v132, v133
v_sin_f32_e64 v133, -v133
v_cos_f32 v134, v135
v_sin_f32_e64 v135, -v135
v_cos_f32 v148, v149
buffer_load_dwordx4 a[80:83], v4, s[16:19], s44 offen offset:2048
v_sin_f32_e64 v149, -v149
v_cos_f32 v150, v151
v_sin_f32_e64 v151, -v151
v_cos_f32 v152, v153
v_sin_f32_e64 v153, -v153
v_cos_f32 v154, v155
v_sin_f32_e64 v155, -v155
s_mov_b32 s62, 0x3ffcd925
s_mov_b32 s63, 0xbfcf1bbd
v_and_b32 v9, 1, v3
v_lshlrev_b32 v9, 31, v9
v_or_b32 v9, 0.5, v9
v_fma_f32 v175, s62, v174, -v173
buffer_load_dwordx4 a[84:87], v4, s[16:19], s44 offen offset:3072
v_fma_f32 v136, v251, v132, -v128
v_fma_f32 v137, v251, v133, -v129
v_fma_f32 v138, v252, v134, -v130
v_fma_f32 v139, v252, v135, -v131
v_fma_f32 v176, s62, v175, -v174
v_fma_f32 v140, v251, v136, -v132
v_fma_f32 v141, v251, v137, -v133
v_fma_f32 v142, v252, v138, -v134
v_fma_f32 v143, v252, v139, -v135
v_fma_f32 v177, s62, v176, -v175
v_fma_f32 v144, v251, v140, -v136
v_fma_f32 v145, v251, v141, -v137
v_fma_f32 v146, v252, v142, -v138
v_fma_f32 v147, v252, v143, -v139
v_fma_f32 v170, s63, v169, -v168
v_fma_f32 v156, v253, v152, -v148
v_fma_f32 v157, v253, v153, -v149
buffer_load_dwordx4 a[88:91], v5, s[16:19], s44 offen offset:0
v_fma_f32 v158, v254, v154, -v150
v_fma_f32 v159, v254, v155, -v151
v_fma_f32 v171, s63, v170, -v169
v_fma_f32 v160, v253, v156, -v152
v_fma_f32 v161, v253, v157, -v153
v_fma_f32 v162, v254, v158, -v154
v_fma_f32 v163, v254, v159, -v155
v_fma_f32 v172, s63, v171, -v170
v_fma_f32 v164, v253, v160, -v156
v_fma_f32 v165, v253, v161, -v157
v_fma_f32 v166, v254, v162, -v158
v_fma_f32 v167, v254, v163, -v159
v_fma_f32 v180, v173, v130, -v128
v_fma_f32 v181, v173, v131, -v129
v_cndmask_b32 v244, v128, 0.5, s[60:61]
v_cndmask_b32 v245, v129, v9, s[60:61]
v_cvt_pk_bf16_f32 v88, v244, v130
s_add_u32 m0, s66, 4096
s_nop 0
buffer_load_dwordx4 v5, s[16:19], s50 offen offset:0 lds
v_cvt_pk_bf16_f32 v90, v245, v131
v_fma_f32 v182, v173, v180, -v130
v_fma_f32 v183, v173, v181, -v131
v_cvt_pk_bf16_f32 v89, v180, v182
v_cvt_pk_bf16_f32 v91, v181, v183
s_waitcnt vmcnt(14)
s_waitcnt vmcnt(13)
ds_read_b64_tr_b16 v[228:229], v8 offset:0
ds_read_b64_tr_b16 v[230:231], v8 offset:1024
ds_read_b64_tr_b16 v[232:233], v8 offset:8
ds_read_b64_tr_b16 v[234:235], v8 offset:1032
ds_read_b64_tr_b16 v[212:213], v0 offset:20992
ds_read_b64_tr_b16 v[214:215], v0 offset:21248
ds_read_b64_tr_b16 v[216:217], v0 offset:21000
ds_read_b64_tr_b16 v[218:219], v0 offset:21256
ds_read_b64_tr_b16 v[236:237], v8 offset:10240
ds_read_b64_tr_b16 v[238:239], v8 offset:11264
ds_read_b64_tr_b16 v[240:241], v8 offset:10248
ds_read_b64_tr_b16 v[242:243], v8 offset:11272
ds_read_b64_tr_b16 v[220:221], v0 offset:20480
ds_read_b64_tr_b16 v[222:223], v0 offset:20736
ds_read_b64_tr_b16 v[224:225], v0 offset:20488
ds_read_b64_tr_b16 v[226:227], v0 offset:20744
v_fma_f32 v184, v174, v134, -v132
buffer_load_dwordx4 v5, s[16:19], s50 offen offset:1024 lds
v_fma_f32 v185, v174, v135, -v133
v_cndmask_b32 v246, v132, 0.5, s[60:61]
v_cndmask_b32 v247, v133, v9, s[60:61]
v_cvt_pk_bf16_f32 v92, v246, v134
v_cvt_pk_bf16_f32 v94, v247, v135
v_fma_f32 v186, v174, v184, -v134
v_fma_f32 v187, v174, v185, -v135
v_cvt_pk_bf16_f32 v93, v184, v186
v_cvt_pk_bf16_f32 v95, v185, v187
v_fma_f32 v180, v175, v138, -v136
v_fma_f32 v181, v175, v139, -v137
s_add_u32 m0, s66, 14336
s_nop 0
buffer_load_dwordx4 v5, s[16:19], s51 offen offset:0 lds
v_cndmask_b32 v244, v136, 0.5, s[60:61]
v_cndmask_b32 v245, v137, v9, s[60:61]
v_cvt_pk_bf16_f32 v96, v244, v138
v_cvt_pk_bf16_f32 v98, v245, v139
v_fma_f32 v182, v175, v180, -v138
v_fma_f32 v183, v175, v181, -v139
v_cvt_pk_bf16_f32 v97, v180, v182
v_cvt_pk_bf16_f32 v99, v181, v183
v_fma_f32 v184, v176, v142, -v140
v_fma_f32 v185, v176, v143, -v141
v_cndmask_b32 v246, v140, 0.5, s[60:61]
v_cndmask_b32 v247, v141, v9, s[60:61]
v_cvt_pk_bf16_f32 v100, v246, v142
v_cvt_pk_bf16_f32 v102, v247, v143
v_fma_f32 v186, v176, v184, -v142
v_fma_f32 v187, v176, v185, -v143
v_cvt_pk_bf16_f32 v101, v184, v186
buffer_load_dwordx4 v5, s[16:19], s51 offen offset:1024 lds
v_cvt_pk_bf16_f32 v103, v185, v187
v_fma_f32 v180, v177, v146, -v144
v_fma_f32 v181, v177, v147, -v145
v_cndmask_b32 v244, v144, 0.5, s[60:61]
v_cndmask_b32 v245, v145, v9, s[60:61]
v_cvt_pk_bf16_f32 v104, v244, v146
v_cvt_pk_bf16_f32 v106, v245, v147
v_fma_f32 v182, v177, v180, -v146
v_fma_f32 v183, v177, v181, -v147
v_cvt_pk_bf16_f32 v105, v180, v182
v_cvt_pk_bf16_f32 v107, v181, v183
s_waitcnt lgkmcnt(8)
v_mfma_f32_16x16x32_bf16 v[188:191], v[228:231], v[40:43], 0
v_cndmask_b32 v112, v232, v212, s[64:65]
v_cndmask_b32 v108, v228, v216, s[64:65]
v_mfma_f32_16x16x32_bf16 v[196:199], v[228:231], v[52:55], 0
v_cndmask_b32 v113, v233, v213, s[64:65]
v_cndmask_b32 v109, v229, v217, s[64:65]
v_mfma_f32_16x16x32_bf16 v[188:191], v[232:235], v[48:51], v[188:191]
v_cndmask_b32 v114, v234, v214, s[64:65]
v_cndmask_b32 v110, v230, v218, s[64:65]
v_mfma_f32_16x16x32_bf16 v[196:199], v[232:235], v[60:63], v[196:199]
v_cndmask_b32 v115, v235, v215, s[64:65]
v_cndmask_b32 v111, v231, v219, s[64:65]
s_waitcnt lgkmcnt(0)
v_mfma_f32_16x16x32_bf16 v[192:195], v[112:115], v[40:43], 0
v_cndmask_b32 v120, v240, v220, s[64:65]
v_cndmask_b32 v116, v236, v224, s[64:65]
v_mfma_f32_16x16x32_bf16 v[200:203], v[112:115], v[52:55], 0
v_cndmask_b32 v121, v241, v221, s[64:65]
v_cndmask_b32 v117, v237, v225, s[64:65]
v_mfma_f32_16x16x32_bf16 v[192:195], v[108:111], v[44:47], v[192:195]
v_cndmask_b32 v122, v242, v222, s[64:65]
v_cndmask_b32 v118, v238, v226, s[64:65]
v_mfma_f32_16x16x32_bf16 v[200:203], v[108:111], v[56:59], v[200:203]
v_cndmask_b32 v123, v243, v223, s[64:65]
v_cndmask_b32 v119, v239, v227, s[64:65]
v_mfma_f32_16x16x32_bf16 v[204:207], v[236:239], v[64:67], 0
buffer_load_dwordx4 a[92:95], v4, s[16:19], s40 offen offset:1024
v_mfma_f32_16x16x32_bf16 v[208:211], v[120:123], v[64:67], 0
buffer_load_dwordx4 a[96:99], v4, s[16:19], s45 offen offset:0
v_mfma_f32_16x16x32_bf16 v[204:207], v[240:243], v[72:75], v[204:207]
v_cvt_pk_bf16_f32 v212, v188, v189
v_cvt_pk_bf16_f32 v213, v190, v191
v_mfma_f32_16x16x32_bf16 v[208:211], v[116:119], v[68:71], v[208:211]
v_cvt_pk_bf16_f32 v214, v192, v193
v_cvt_pk_bf16_f32 v215, v194, v195
v_mfma_f32_16x16x32_bf16 v[188:191], v[236:239], v[76:79], 0
v_cvt_pk_bf16_f32 v216, v196, v197
v_cvt_pk_bf16_f32 v217, v198, v199
v_mfma_f32_16x16x32_bf16 v[192:195], v[120:123], v[76:79], 0
v_cvt_pk_bf16_f32 v218, v200, v201
v_cvt_pk_bf16_f32 v219, v202, v203
v_mfma_f32_16x16x32_bf16 v[188:191], v[240:243], v[84:87], v[188:191]
buffer_load_dwordx4 a[100:103], v4, s[16:19], s41 offen offset:1024
v_mfma_f32_16x16x32_bf16 v[192:195], v[116:119], v[80:83], v[192:195]
v_mfma_f32_16x16x32_bf16 a[0:3], v[88:91], v[212:215], 0
v_cvt_pk_bf16_f32 v220, v204, v205
v_cvt_pk_bf16_f32 v221, v206, v207
v_mfma_f32_16x16x32_bf16 a[4:7], v[92:95], v[212:215], 0
v_cvt_pk_bf16_f32 v222, v208, v209
v_cvt_pk_bf16_f32 v223, v210, v211
v_mfma_f32_16x16x32_bf16 a[8:11], v[96:99], v[212:215], 0
buffer_load_dwordx4 a[104:107], v4, s[16:19], s42 offen offset:1024
v_mfma_f32_16x16x32_bf16 a[12:15], v[100:103], v[212:215], 0
v_fma_f32 v180, v173, v150, -v148
v_fma_f32 v181, v173, v151, -v149
v_mfma_f32_16x16x32_bf16 a[16:19], v[104:107], v[212:215], 0
v_cvt_pk_bf16_f32 v108, v148, v150
v_cvt_pk_bf16_f32 v110, v149, v151
v_mfma_f32_16x16x32_bf16 a[20:23], v[88:91], v[216:219], 0
v_cvt_pk_bf16_f32 v224, v188, v189
v_cvt_pk_bf16_f32 v225, v190, v191
v_mfma_f32_16x16x32_bf16 a[24:27], v[92:95], v[216:219], 0
v_cvt_pk_bf16_f32 v226, v192, v193
v_cvt_pk_bf16_f32 v227, v194, v195
v_mfma_f32_16x16x32_bf16 a[28:31], v[96:99], v[216:219], 0
buffer_load_dwordx4 a[108:111], v4, s[16:19], s45 offen offset:1024
v_mfma_f32_16x16x32_bf16 a[32:35], v[100:103], v[216:219], 0
v_fma_f32 v182, v173, v180, -v150
v_fma_f32 v183, v173, v181, -v151
v_mfma_f32_16x16x32_bf16 a[36:39], v[104:107], v[216:219], 0
v_cvt_pk_bf16_f32 v109, v180, v182
v_cvt_pk_bf16_f32 v111, v181, v183
s_waitcnt vmcnt(17)
v_mfma_f32_16x16x32_bf16 a[40:43], v[88:91], v[220:223], 0
ds_read_b64_tr_b16 v[228:229], v8 offset:2048
ds_read_b64_tr_b16 v[230:231], v8 offset:3072
v_mfma_f32_16x16x32_bf16 a[44:47], v[92:95], v[220:223], 0
ds_read_b64_tr_b16 v[232:233], v8 offset:2056
ds_read_b64_tr_b16 v[234:235], v8 offset:3080
v_mfma_f32_16x16x32_bf16 a[48:51], v[96:99], v[220:223], 0
ds_read_b64_tr_b16 v[236:237], v8 offset:12288
ds_read_b64_tr_b16 v[238:239], v8 offset:13312
v_mfma_f32_16x16x32_bf16 a[52:55], v[100:103], v[220:223], 0
ds_read_b64_tr_b16 v[240:241], v8 offset:12296
ds_read_b64_tr_b16 v[242:243], v8 offset:13320
v_mfma_f32_16x16x32_bf16 a[56:59], v[104:107], v[220:223], 0
buffer_load_dwordx4 a[112:115], v4, s[16:19], s45 offen offset:2048
v_mfma_f32_16x16x32_bf16 v[20:23], v[88:91], v[224:227], 0
v_fma_f32 v184, v174, v154, -v152
v_fma_f32 v185, v174, v155, -v153
v_mfma_f32_16x16x32_bf16 v[24:27], v[92:95], v[224:227], 0
v_cvt_pk_bf16_f32 v112, v152, v154
v_cvt_pk_bf16_f32 v114, v153, v155
v_mfma_f32_16x16x32_bf16 v[28:31], v[96:99], v[224:227], 0
buffer_load_dwordx4 a[116:119], v4, s[16:19], s45 offen offset:3072
v_mfma_f32_16x16x32_bf16 v[32:35], v[100:103], v[224:227], 0
v_fma_f32 v186, v174, v184, -v154
v_fma_f32 v187, v174, v185, -v155
v_mfma_f32_16x16x32_bf16 v[36:39], v[104:107], v[224:227], 0
v_cvt_pk_bf16_f32 v113, v184, v186
v_cvt_pk_bf16_f32 v115, v185, v187
s_waitcnt lgkmcnt(4)
v_mfma_f32_16x16x32_bf16 v[188:191], v[228:231], v[40:43], 0
v_fma_f32 v180, v175, v158, -v156
v_fma_f32 v181, v175, v159, -v157
v_mfma_f32_16x16x32_bf16 v[192:195], v[232:235], v[40:43], 0
v_cvt_pk_bf16_f32 v116, v156, v158
v_cvt_pk_bf16_f32 v118, v157, v159
v_mfma_f32_16x16x32_bf16 v[188:191], v[232:235], v[48:51], v[188:191]
buffer_load_dwordx4 a[120:123], v5, s[16:19], s45 offen offset:0
v_mfma_f32_16x16x32_bf16 v[192:195], v[228:231], v[44:47], v[192:195]
v_fma_f32 v182, v175, v180, -v158
v_fma_f32 v183, v175, v181, -v159
v_mfma_f32_16x16x32_bf16 v[196:199], v[228:231], v[52:55], 0
v_cvt_pk_bf16_f32 v117, v180, v182
v_cvt_pk_bf16_f32 v119, v181, v183
v_mfma_f32_16x16x32_bf16 v[200:203], v[232:235], v[52:55], 0
v_fma_f32 v184, v176, v162, -v160
v_fma_f32 v185, v176, v163, -v161
v_mfma_f32_16x16x32_bf16 v[196:199], v[232:235], v[60:63], v[196:199]
v_cvt_pk_bf16_f32 v120, v160, v162
v_cvt_pk_bf16_f32 v122, v161, v163
v_mfma_f32_16x16x32_bf16 v[200:203], v[228:231], v[56:59], v[200:203]
s_add_u32 m0, s66, 4096
s_nop 0
buffer_load_dwordx4 v5, s[16:19], s50 offen offset:2048 lds
s_waitcnt lgkmcnt(0)
v_mfma_f32_16x16x32_bf16 v[204:207], v[236:239], v[64:67], 0
v_cvt_pk_bf16_f32 v212, v188, v189
v_cvt_pk_bf16_f32 v213, v190, v191
v_mfma_f32_16x16x32_bf16 v[208:211], v[240:243], v[64:67], 0
v_cvt_pk_bf16_f32 v214, v192, v193
v_cvt_pk_bf16_f32 v215, v194, v195
v_mfma_f32_16x16x32_bf16 v[204:207], v[240:243], v[72:75], v[204:207]
v_fma_f32 v186, v176, v184, -v162
v_fma_f32 v187, v176, v185, -v163
v_mfma_f32_16x16x32_bf16 v[208:211], v[236:239], v[68:71], v[208:211]
v_cvt_pk_bf16_f32 v121, v184, v186
v_cvt_pk_bf16_f32 v123, v185, v187
v_mfma_f32_16x16x32_bf16 v[188:191], v[236:239], v[76:79], 0
v_cvt_pk_bf16_f32 v216, v196, v197
v_cvt_pk_bf16_f32 v217, v198, v199
v_mfma_f32_16x16x32_bf16 v[192:195], v[240:243], v[76:79], 0
v_cvt_pk_bf16_f32 v218, v200, v201
v_cvt_pk_bf16_f32 v219, v202, v203
v_mfma_f32_16x16x32_bf16 v[188:191], v[240:243], v[84:87], v[188:191]
buffer_load_dwordx4 v5, s[16:19], s50 offen offset:3072 lds
v_mfma_f32_16x16x32_bf16 v[192:195], v[236:239], v[80:83], v[192:195]
v_fma_f32 v180, v177, v166, -v164
v_fma_f32 v181, v177, v167, -v165
v_cvt_pk_bf16_f32 v124, v164, v166
v_cvt_pk_bf16_f32 v126, v165, v167
v_fma_f32 v182, v177, v180, -v166
v_fma_f32 v183, v177, v181, -v167
v_cvt_pk_bf16_f32 v125, v180, v182
v_cvt_pk_bf16_f32 v127, v181, v183
v_mfma_f32_16x16x32_bf16 a[0:3], v[108:111], v[212:215], a[0:3]
v_cvt_pk_bf16_f32 v220, v204, v205
v_cvt_pk_bf16_f32 v221, v206, v207
v_mfma_f32_16x16x32_bf16 a[4:7], v[112:115], v[212:215], a[4:7]
v_cvt_pk_bf16_f32 v222, v208, v209
v_cvt_pk_bf16_f32 v223, v210, v211
v_mfma_f32_16x16x32_bf16 a[8:11], v[116:119], v[212:215], a[8:11]
s_add_u32 m0, s66, 14336
s_nop 0
buffer_load_dwordx4 v5, s[16:19], s51 offen offset:2048 lds
v_mfma_f32_16x16x32_bf16 a[12:15], v[120:123], v[212:215], a[12:15]
v_fma_f32 v128, v168, v148, -v128
v_fma_f32 v129, v168, v149, -v129
v_mfma_f32_16x16x32_bf16 a[16:19], v[124:127], v[212:215], a[16:19]
v_fma_f32 v130, v168, v150, -v130
v_fma_f32 v131, v168, v151, -v131
v_mfma_f32_16x16x32_bf16 a[20:23], v[108:111], v[216:219], a[20:23]
v_cvt_pk_bf16_f32 v224, v188, v189
v_cvt_pk_bf16_f32 v225, v190, v191
v_mfma_f32_16x16x32_bf16 a[24:27], v[112:115], v[216:219], a[24:27]
v_cvt_pk_bf16_f32 v226, v192, v193
v_cvt_pk_bf16_f32 v227, v194, v195
v_mfma_f32_16x16x32_bf16 a[28:31], v[116:119], v[216:219], a[28:31]
buffer_load_dwordx4 v5, s[16:19], s51 offen offset:3072 lds
v_mfma_f32_16x16x32_bf16 a[32:35], v[120:123], v[216:219], a[32:35]
v_fma_f32 v132, v169, v152, -v132
v_fma_f32 v133, v169, v153, -v133
v_mfma_f32_16x16x32_bf16 a[36:39], v[124:127], v[216:219], a[36:39]
v_fma_f32 v134, v169, v154, -v134
v_fma_f32 v135, v169, v155, -v135
v_mfma_f32_16x16x32_bf16 a[40:43], v[108:111], v[220:223], a[40:43]
buffer_load_dwordx4 a[124:127], v4, s[16:19], s40 offen offset:2048
v_mfma_f32_16x16x32_bf16 a[44:47], v[112:115], v[220:223], a[44:47]
v_fma_f32 v136, v170, v156, -v136
v_fma_f32 v137, v170, v157, -v137
v_mfma_f32_16x16x32_bf16 a[48:51], v[116:119], v[220:223], a[48:51]
v_fma_f32 v138, v170, v158, -v138
v_fma_f32 v139, v170, v159, -v139
v_mfma_f32_16x16x32_bf16 a[52:55], v[120:123], v[220:223], a[52:55]
v_fma_f32 v140, v171, v160, -v140
v_fma_f32 v141, v171, v161, -v141
v_mfma_f32_16x16x32_bf16 a[56:59], v[124:127], v[220:223], a[56:59]
v_fma_f32 v142, v171, v162, -v142
v_fma_f32 v143, v171, v163, -v143
v_mfma_f32_16x16x32_bf16 v[20:23], v[108:111], v[224:227], v[20:23]
buffer_load_dwordx4 a[128:131], v4, s[16:19], s46 offen offset:0
v_mfma_f32_16x16x32_bf16 v[24:27], v[112:115], v[224:227], v[24:27]
v_fma_f32 v144, v172, v164, -v144
v_fma_f32 v145, v172, v165, -v145
v_mfma_f32_16x16x32_bf16 v[28:31], v[116:119], v[224:227], v[28:31]
v_fma_f32 v146, v172, v166, -v146
v_fma_f32 v147, v172, v167, -v147
v_mfma_f32_16x16x32_bf16 v[32:35], v[120:123], v[224:227], v[32:35]
v_fma_f32 v180, v173, v130, -v128
v_fma_f32 v181, v173, v131, -v129
v_mfma_f32_16x16x32_bf16 v[36:39], v[124:127], v[224:227], v[36:39]
v_cvt_pk_bf16_f32 v88, v128, v130
v_cvt_pk_bf16_f32 v90, v129, v131
s_waitcnt vmcnt(24)
v_mfma_f32_16x16x32_bf16 a[0:3], a[64:67], a[60:63], a[0:3]
buffer_load_dwordx4 a[132:135], v4, s[16:19], s41 offen offset:2048
s_waitcnt vmcnt(24)
v_mfma_f32_16x16x32_bf16 a[20:23], a[64:67], a[68:71], a[20:23]
v_fma_f32 v182, v173, v180, -v130
v_fma_f32 v183, v173, v181, -v131
s_waitcnt vmcnt(23)
v_mfma_f32_16x16x32_bf16 a[40:43], a[64:67], a[72:75], a[40:43]
v_cvt_pk_bf16_f32 v89, v180, v182
v_cvt_pk_bf16_f32 v91, v181, v183
s_waitcnt vmcnt(22)
v_mfma_f32_16x16x32_bf16 a[4:7], a[76:79], a[60:63], a[4:7]
v_fma_f32 v184, v174, v134, -v132
v_fma_f32 v185, v174, v135, -v133
v_mfma_f32_16x16x32_bf16 a[24:27], a[76:79], a[68:71], a[24:27]
v_cvt_pk_bf16_f32 v92, v132, v134
v_cvt_pk_bf16_f32 v94, v133, v135
v_mfma_f32_16x16x32_bf16 a[44:47], a[76:79], a[72:75], a[44:47]
buffer_load_dwordx4 a[136:139], v4, s[16:19], s42 offen offset:2048
s_waitcnt vmcnt(16)
v_mfma_f32_16x16x32_bf16 a[8:11], a[80:83], a[60:63], a[8:11]
ds_read_b64_tr_b16 v[228:229], v8 offset:4096
ds_read_b64_tr_b16 v[230:231], v8 offset:5120
v_mfma_f32_16x16x32_bf16 a[28:31], a[80:83], a[68:71], a[28:31]
ds_read_b64_tr_b16 v[232:233], v8 offset:4104
ds_read_b64_tr_b16 v[234:235], v8 offset:5128
v_mfma_f32_16x16x32_bf16 a[48:51], a[80:83], a[72:75], a[48:51]
ds_read_b64_tr_b16 v[236:237], v8 offset:14336
ds_read_b64_tr_b16 v[238:239], v8 offset:15360
v_mfma_f32_16x16x32_bf16 a[12:15], a[84:87], a[60:63], a[12:15]
ds_read_b64_tr_b16 v[240:241], v8 offset:14344
ds_read_b64_tr_b16 v[242:243], v8 offset:15368
v_mfma_f32_16x16x32_bf16 a[32:35], a[84:87], a[68:71], a[32:35]
buffer_load_dwordx4 a[140:143], v4, s[16:19], s46 offen offset:1024
v_mfma_f32_16x16x32_bf16 a[52:55], a[84:87], a[72:75], a[52:55]
v_fma_f32 v186, v174, v184, -v134
v_fma_f32 v187, v174, v185, -v135
v_mfma_f32_16x16x32_bf16 a[16:19], a[88:91], a[60:63], a[16:19]
v_cvt_pk_bf16_f32 v93, v184, v186
v_cvt_pk_bf16_f32 v95, v185, v187
v_mfma_f32_16x16x32_bf16 a[36:39], a[88:91], a[68:71], a[36:39]
v_fma_f32 v180, v175, v138, -v136
v_fma_f32 v181, v175, v139, -v137
v_mfma_f32_16x16x32_bf16 a[56:59], a[88:91], a[72:75], a[56:59]
v_cvt_pk_bf16_f32 v96, v136, v138
v_cvt_pk_bf16_f32 v98, v137, v139
s_waitcnt lgkmcnt(4)
v_mfma_f32_16x16x32_bf16 v[188:191], v[228:231], v[40:43], 0
buffer_load_dwordx4 a[144:147], v4, s[16:19], s46 offen offset:2048
v_mfma_f32_16x16x32_bf16 v[192:195], v[232:235], v[40:43], 0
v_fma_f32 v182, v175, v180, -v138
v_fma_f32 v183, v175, v181, -v139
v_mfma_f32_16x16x32_bf16 v[188:191], v[232:235], v[48:51], v[188:191]
v_cvt_pk_bf16_f32 v97, v180, v182
v_cvt_pk_bf16_f32 v99, v181, v183
v_mfma_f32_16x16x32_bf16 v[192:195], v[228:231], v[44:47], v[192:195]
v_fma_f32 v184, v176, v142, -v140
v_fma_f32 v185, v176, v143, -v141
v_mfma_f32_16x16x32_bf16 v[196:199], v[228:231], v[52:55], 0
v_cvt_pk_bf16_f32 v100, v140, v142
v_cvt_pk_bf16_f32 v102, v141, v143
v_mfma_f32_16x16x32_bf16 v[200:203], v[232:235], v[52:55], 0
v_fma_f32 v186, v176, v184, -v142
v_fma_f32 v187, v176, v185, -v143
v_mfma_f32_16x16x32_bf16 v[196:199], v[232:235], v[60:63], v[196:199]
buffer_load_dwordx4 a[148:151], v4, s[16:19], s46 offen offset:3072
v_mfma_f32_16x16x32_bf16 v[200:203], v[228:231], v[56:59], v[200:203]
v_cvt_pk_bf16_f32 v101, v184, v186
v_cvt_pk_bf16_f32 v103, v185, v187
s_waitcnt lgkmcnt(0)
v_mfma_f32_16x16x32_bf16 v[204:207], v[236:239], v[64:67], 0
v_cvt_pk_bf16_f32 v212, v188, v189
v_cvt_pk_bf16_f32 v213, v190, v191
v_mfma_f32_16x16x32_bf16 v[208:211], v[240:243], v[64:67], 0
v_cvt_pk_bf16_f32 v214, v192, v193
v_cvt_pk_bf16_f32 v215, v194, v195
v_mfma_f32_16x16x32_bf16 v[204:207], v[240:243], v[72:75], v[204:207]
v_fma_f32 v180, v177, v146, -v144
v_fma_f32 v181, v177, v147, -v145
v_mfma_f32_16x16x32_bf16 v[208:211], v[236:239], v[68:71], v[208:211]
buffer_load_dwordx4 a[152:155], v5, s[16:19], s46 offen offset:0
v_mfma_f32_16x16x32_bf16 v[188:191], v[236:239], v[76:79], 0
v_cvt_pk_bf16_f32 v216, v196, v197
v_cvt_pk_bf16_f32 v217, v198, v199
v_mfma_f32_16x16x32_bf16 v[192:195], v[240:243], v[76:79], 0
v_cvt_pk_bf16_f32 v218, v200, v201
v_cvt_pk_bf16_f32 v219, v202, v203
v_mfma_f32_16x16x32_bf16 v[188:191], v[240:243], v[84:87], v[188:191]
v_cvt_pk_bf16_f32 v104, v144, v146
v_cvt_pk_bf16_f32 v106, v145, v147
v_mfma_f32_16x16x32_bf16 v[192:195], v[236:239], v[80:83], v[192:195]
v_fma_f32 v182, v177, v180, -v146
v_fma_f32 v183, v177, v181, -v147
v_cvt_pk_bf16_f32 v105, v180, v182
v_cvt_pk_bf16_f32 v107, v181, v183
v_mfma_f32_16x16x32_bf16 a[0:3], v[88:91], v[212:215], a[0:3]
v_cvt_pk_bf16_f32 v220, v204, v205
v_cvt_pk_bf16_f32 v221, v206, v207
v_mfma_f32_16x16x32_bf16 a[4:7], v[92:95], v[212:215], a[4:7]
v_cvt_pk_bf16_f32 v222, v208, v209
v_cvt_pk_bf16_f32 v223, v210, v211
v_mfma_f32_16x16x32_bf16 a[8:11], v[96:99], v[212:215], a[8:11]
s_add_u32 m0, s66, 8192
s_nop 0
buffer_load_dwordx4 v6, s[16:19], s50 offen offset:0 lds
v_mfma_f32_16x16x32_bf16 a[12:15], v[100:103], v[212:215], a[12:15]
v_fma_f32 v148, v168, v128, -v148
v_fma_f32 v149, v168, v129, -v149
v_mfma_f32_16x16x32_bf16 a[16:19], v[104:107], v[212:215], a[16:19]
v_fma_f32 v150, v168, v130, -v150
v_fma_f32 v151, v168, v131, -v151
v_mfma_f32_16x16x32_bf16 a[20:23], v[88:91], v[216:219], a[20:23]
v_cvt_pk_bf16_f32 v224, v188, v189
v_cvt_pk_bf16_f32 v225, v190, v191
v_mfma_f32_16x16x32_bf16 a[24:27], v[92:95], v[216:219], a[24:27]
v_cvt_pk_bf16_f32 v226, v192, v193
v_cvt_pk_bf16_f32 v227, v194, v195
v_mfma_f32_16x16x32_bf16 a[28:31], v[96:99], v[216:219], a[28:31]
buffer_load_dwordx4 v6, s[16:19], s50 offen offset:1024 lds
v_mfma_f32_16x16x32_bf16 a[32:35], v[100:103], v[216:219], a[32:35]
v_fma_f32 v152, v169, v132, -v152
v_fma_f32 v153, v169, v133, -v153
v_mfma_f32_16x16x32_bf16 a[36:39], v[104:107], v[216:219], a[36:39]
v_fma_f32 v154, v169, v134, -v154
v_fma_f32 v155, v169, v135, -v155
v_mfma_f32_16x16x32_bf16 a[40:43], v[88:91], v[220:223], a[40:43]
s_add_u32 m0, s66, 18432
s_nop 0
buffer_load_dwordx4 v6, s[16:19], s51 offen offset:0 lds
v_mfma_f32_16x16x32_bf16 a[44:47], v[92:95], v[220:223], a[44:47]
v_fma_f32 v156, v170, v136, -v156
v_fma_f32 v157, v170, v137, -v157
v_mfma_f32_16x16x32_bf16 a[48:51], v[96:99], v[220:223], a[48:51]
v_fma_f32 v158, v170, v138, -v158
v_fma_f32 v159, v170, v139, -v159
v_mfma_f32_16x16x32_bf16 a[52:55], v[100:103], v[220:223], a[52:55]
v_fma_f32 v160, v171, v140, -v160
v_fma_f32 v161, v171, v141, -v161
v_mfma_f32_16x16x32_bf16 a[56:59], v[104:107], v[220:223], a[56:59]
v_fma_f32 v162, v171, v142, -v162
v_fma_f32 v163, v171, v143, -v163
v_mfma_f32_16x16x32_bf16 v[20:23], v[88:91], v[224:227], v[20:23]
buffer_load_dwordx4 v6, s[16:19], s51 offen offset:1024 lds
v_mfma_f32_16x16x32_bf16 v[24:27], v[92:95], v[224:227], v[24:27]
v_fma_f32 v164, v172, v144, -v164
v_fma_f32 v165, v172, v145, -v165
v_mfma_f32_16x16x32_bf16 v[28:31], v[96:99], v[224:227], v[28:31]
v_fma_f32 v166, v172, v146, -v166
v_fma_f32 v167, v172, v147, -v167
v_mfma_f32_16x16x32_bf16 v[32:35], v[100:103], v[224:227], v[32:35]
v_fma_f32 v180, v173, v150, -v148
v_fma_f32 v181, v173, v151, -v149
v_mfma_f32_16x16x32_bf16 v[36:39], v[104:107], v[224:227], v[36:39]
v_cvt_pk_bf16_f32 v108, v148, v150
v_cvt_pk_bf16_f32 v110, v149, v151
s_waitcnt vmcnt(22)
v_mfma_f32_16x16x32_bf16 a[0:3], a[96:99], a[92:95], a[0:3]
buffer_load_dwordx4 a[156:159], v4, s[16:19], s47 offen offset:0
s_waitcnt vmcnt(22)
v_mfma_f32_16x16x32_bf16 a[20:23], a[96:99], a[100:103], a[20:23]
v_fma_f32 v182, v173, v180, -v150
v_fma_f32 v183, v173, v181, -v151
s_waitcnt vmcnt(21)
v_mfma_f32_16x16x32_bf16 a[40:43], a[96:99], a[104:107], a[40:43]
v_cvt_pk_bf16_f32 v109, v180, v182
v_cvt_pk_bf16_f32 v111, v181, v183
s_waitcnt vmcnt(20)
v_mfma_f32_16x16x32_bf16 a[4:7], a[108:111], a[92:95], a[4:7]
v_fma_f32 v184, v174, v154, -v152
v_fma_f32 v185, v174, v155, -v153
v_mfma_f32_16x16x32_bf16 a[24:27], a[108:111], a[100:103], a[24:27]
v_cvt_pk_bf16_f32 v112, v152, v154
v_cvt_pk_bf16_f32 v114, v153, v155
v_mfma_f32_16x16x32_bf16 a[44:47], a[108:111], a[104:107], a[44:47]
buffer_load_dwordx4 a[160:163], v4, s[16:19], s47 offen offset:1024
s_waitcnt vmcnt(14)
v_mfma_f32_16x16x32_bf16 a[8:11], a[112:115], a[92:95], a[8:11]
ds_read_b64_tr_b16 v[228:229], v8 offset:6144
ds_read_b64_tr_b16 v[230:231], v8 offset:7168
v_mfma_f32_16x16x32_bf16 a[28:31], a[112:115], a[100:103], a[28:31]
ds_read_b64_tr_b16 v[232:233], v8 offset:6152
ds_read_b64_tr_b16 v[234:235], v8 offset:7176
v_mfma_f32_16x16x32_bf16 a[48:51], a[112:115], a[104:107], a[48:51]
ds_read_b64_tr_b16 v[236:237], v8 offset:16384
ds_read_b64_tr_b16 v[238:239], v8 offset:17408
v_mfma_f32_16x16x32_bf16 a[12:15], a[116:119], a[92:95], a[12:15]
ds_read_b64_tr_b16 v[240:241], v8 offset:16392
ds_read_b64_tr_b16 v[242:243], v8 offset:17416
v_mfma_f32_16x16x32_bf16 a[32:35], a[116:119], a[100:103], a[32:35]
buffer_load_dwordx4 a[164:167], v4, s[16:19], s47 offen offset:2048
v_mfma_f32_16x16x32_bf16 a[52:55], a[116:119], a[104:107], a[52:55]
v_fma_f32 v186, v174, v184, -v154
v_fma_f32 v187, v174, v185, -v155
v_mfma_f32_16x16x32_bf16 a[16:19], a[120:123], a[92:95], a[16:19]
v_cvt_pk_bf16_f32 v113, v184, v186
v_cvt_pk_bf16_f32 v115, v185, v187
v_mfma_f32_16x16x32_bf16 a[36:39], a[120:123], a[100:103], a[36:39]
v_fma_f32 v180, v175, v158, -v156
v_fma_f32 v181, v175, v159, -v157
v_mfma_f32_16x16x32_bf16 a[56:59], a[120:123], a[104:107], a[56:59]
v_cvt_pk_bf16_f32 v116, v156, v158
v_cvt_pk_bf16_f32 v118, v157, v159
s_waitcnt lgkmcnt(4)
v_mfma_f32_16x16x32_bf16 v[188:191], v[228:231], v[40:43], 0
buffer_load_dwordx4 a[168:171], v4, s[16:19], s47 offen offset:3072
v_mfma_f32_16x16x32_bf16 v[192:195], v[232:235], v[40:43], 0
v_fma_f32 v182, v175, v180, -v158
v_fma_f32 v183, v175, v181, -v159
v_mfma_f32_16x16x32_bf16 v[188:191], v[232:235], v[48:51], v[188:191]
v_cvt_pk_bf16_f32 v117, v180, v182
v_cvt_pk_bf16_f32 v119, v181, v183
v_mfma_f32_16x16x32_bf16 v[192:195], v[228:231], v[44:47], v[192:195]
v_fma_f32 v184, v176, v162, -v160
v_fma_f32 v185, v176, v163, -v161
v_mfma_f32_16x16x32_bf16 v[196:199], v[228:231], v[52:55], 0
v_cvt_pk_bf16_f32 v120, v160, v162
v_cvt_pk_bf16_f32 v122, v161, v163
v_mfma_f32_16x16x32_bf16 v[200:203], v[232:235], v[52:55], 0
buffer_load_dwordx4 a[172:175], v5, s[16:19], s47 offen offset:0
v_mfma_f32_16x16x32_bf16 v[196:199], v[232:235], v[60:63], v[196:199]
v_fma_f32 v186, v176, v184, -v162
v_fma_f32 v187, v176, v185, -v163
v_mfma_f32_16x16x32_bf16 v[200:203], v[228:231], v[56:59], v[200:203]
v_cvt_pk_bf16_f32 v121, v184, v186
v_cvt_pk_bf16_f32 v123, v185, v187
s_waitcnt lgkmcnt(0)
v_mfma_f32_16x16x32_bf16 v[204:207], v[236:239], v[64:67], 0
v_cvt_pk_bf16_f32 v212, v188, v189
v_cvt_pk_bf16_f32 v213, v190, v191
v_mfma_f32_16x16x32_bf16 v[208:211], v[240:243], v[64:67], 0
v_cvt_pk_bf16_f32 v214, v192, v193
v_cvt_pk_bf16_f32 v215, v194, v195
v_mfma_f32_16x16x32_bf16 v[204:207], v[240:243], v[72:75], v[204:207]
v_fma_f32 v180, v177, v166, -v164
v_fma_f32 v181, v177, v167, -v165
v_mfma_f32_16x16x32_bf16 v[208:211], v[236:239], v[68:71], v[208:211]
buffer_load_dwordx4 a[176:179], v4, s[16:19], s40 offen offset:3072
v_mfma_f32_16x16x32_bf16 v[188:191], v[236:239], v[76:79], 0
v_cvt_pk_bf16_f32 v216, v196, v197
v_cvt_pk_bf16_f32 v217, v198, v199
v_mfma_f32_16x16x32_bf16 v[192:195], v[240:243], v[76:79], 0
v_cvt_pk_bf16_f32 v218, v200, v201
v_cvt_pk_bf16_f32 v219, v202, v203
v_mfma_f32_16x16x32_bf16 v[188:191], v[240:243], v[84:87], v[188:191]
v_cvt_pk_bf16_f32 v124, v164, v166
v_cvt_pk_bf16_f32 v126, v165, v167
v_mfma_f32_16x16x32_bf16 v[192:195], v[236:239], v[80:83], v[192:195]
v_fma_f32 v182, v177, v180, -v166
v_fma_f32 v183, v177, v181, -v167
v_cvt_pk_bf16_f32 v125, v180, v182
v_cvt_pk_bf16_f32 v127, v181, v183
v_mfma_f32_16x16x32_bf16 a[0:3], v[108:111], v[212:215], a[0:3]
v_cvt_pk_bf16_f32 v220, v204, v205
v_cvt_pk_bf16_f32 v221, v206, v207
v_mfma_f32_16x16x32_bf16 a[4:7], v[112:115], v[212:215], a[4:7]
v_cvt_pk_bf16_f32 v222, v208, v209
v_cvt_pk_bf16_f32 v223, v210, v211
v_mfma_f32_16x16x32_bf16 a[8:11], v[116:119], v[212:215], a[8:11]
buffer_load_dwordx4 a[180:183], v4, s[16:19], s48 offen offset:0
v_mfma_f32_16x16x32_bf16 a[12:15], v[120:123], v[212:215], a[12:15]
v_fma_f32 v128, v168, v148, -v128
v_fma_f32 v129, v168, v149, -v129
v_mfma_f32_16x16x32_bf16 a[16:19], v[124:127], v[212:215], a[16:19]
buffer_load_dwordx4 a[184:187], v4, s[16:19], s48 offen offset:1024
v_mfma_f32_16x16x32_bf16 a[20:23], v[108:111], v[216:219], a[20:23]
v_cvt_pk_bf16_f32 v224, v188, v189
v_cvt_pk_bf16_f32 v225, v190, v191
v_mfma_f32_16x16x32_bf16 a[24:27], v[112:115], v[216:219], a[24:27]
v_cvt_pk_bf16_f32 v226, v192, v193
v_cvt_pk_bf16_f32 v227, v194, v195
v_mfma_f32_16x16x32_bf16 a[28:31], v[116:119], v[216:219], a[28:31]
v_fma_f32 v130, v168, v150, -v130
v_fma_f32 v131, v168, v151, -v131
v_mfma_f32_16x16x32_bf16 a[32:35], v[120:123], v[216:219], a[32:35]
v_fma_f32 v132, v169, v152, -v132
v_fma_f32 v133, v169, v153, -v133
v_mfma_f32_16x16x32_bf16 a[36:39], v[124:127], v[216:219], a[36:39]
v_fma_f32 v134, v169, v154, -v134
v_fma_f32 v135, v169, v155, -v135
v_mfma_f32_16x16x32_bf16 a[40:43], v[108:111], v[220:223], a[40:43]
buffer_load_dwordx4 a[188:191], v4, s[16:19], s48 offen offset:2048
v_mfma_f32_16x16x32_bf16 a[44:47], v[112:115], v[220:223], a[44:47]
v_fma_f32 v136, v170, v156, -v136
v_fma_f32 v137, v170, v157, -v137
v_mfma_f32_16x16x32_bf16 a[48:51], v[116:119], v[220:223], a[48:51]
v_fma_f32 v138, v170, v158, -v138
v_fma_f32 v139, v170, v159, -v139
v_mfma_f32_16x16x32_bf16 a[52:55], v[120:123], v[220:223], a[52:55]
v_fma_f32 v140, v171, v160, -v140
v_fma_f32 v141, v171, v161, -v141
v_mfma_f32_16x16x32_bf16 a[56:59], v[124:127], v[220:223], a[56:59]
v_fma_f32 v142, v171, v162, -v142
v_fma_f32 v143, v171, v163, -v143
v_mfma_f32_16x16x32_bf16 v[20:23], v[108:111], v[224:227], v[20:23]
buffer_load_dwordx4 a[192:195], v4, s[16:19], s48 offen offset:3072
v_mfma_f32_16x16x32_bf16 v[24:27], v[112:115], v[224:227], v[24:27]
v_fma_f32 v144, v172, v164, -v144
v_fma_f32 v145, v172, v165, -v145
v_mfma_f32_16x16x32_bf16 v[28:31], v[116:119], v[224:227], v[28:31]
v_fma_f32 v146, v172, v166, -v146
v_fma_f32 v147, v172, v167, -v147
v_mfma_f32_16x16x32_bf16 v[32:35], v[120:123], v[224:227], v[32:35]
v_fma_f32 v180, v173, v130, -v128
v_fma_f32 v181, v173, v131, -v129
v_mfma_f32_16x16x32_bf16 v[36:39], v[124:127], v[224:227], v[36:39]
v_cvt_pk_bf16_f32 v88, v128, v130
v_cvt_pk_bf16_f32 v90, v129, v131
s_waitcnt vmcnt(20)
v_mfma_f32_16x16x32_bf16 a[0:3], a[128:131], a[124:127], a[0:3]
buffer_load_dwordx4 a[196:199], v5, s[16:19], s48 offen offset:0
s_waitcnt vmcnt(20)
v_mfma_f32_16x16x32_bf16 a[20:23], a[128:131], a[132:135], a[20:23]
v_fma_f32 v182, v173, v180, -v130
v_fma_f32 v183, v173, v181, -v131
s_waitcnt vmcnt(19)
v_mfma_f32_16x16x32_bf16 a[40:43], a[128:131], a[136:139], a[40:43]
v_cvt_pk_bf16_f32 v89, v180, v182
v_cvt_pk_bf16_f32 v91, v181, v183
s_waitcnt vmcnt(18)
v_mfma_f32_16x16x32_bf16 a[4:7], a[140:143], a[124:127], a[4:7]
v_fma_f32 v184, v174, v134, -v132
v_fma_f32 v185, v174, v135, -v133
v_mfma_f32_16x16x32_bf16 a[24:27], a[140:143], a[132:135], a[24:27]
v_cvt_pk_bf16_f32 v92, v132, v134
v_cvt_pk_bf16_f32 v94, v133, v135
v_mfma_f32_16x16x32_bf16 a[44:47], a[140:143], a[136:139], a[44:47]
buffer_load_dwordx4 a[200:203], v5, s[16:19], s40 offen offset:0
s_waitcnt vmcnt(12)
v_mfma_f32_16x16x32_bf16 a[8:11], a[144:147], a[124:127], a[8:11]
ds_read_b64_tr_b16 v[228:229], v8 offset:8192
ds_read_b64_tr_b16 v[230:231], v8 offset:9216
v_mfma_f32_16x16x32_bf16 a[28:31], a[144:147], a[132:135], a[28:31]
ds_read_b64_tr_b16 v[232:233], v8 offset:8200
ds_read_b64_tr_b16 v[234:235], v8 offset:9224
v_mfma_f32_16x16x32_bf16 a[48:51], a[144:147], a[136:139], a[48:51]
ds_read_b64_tr_b16 v[236:237], v8 offset:18432
ds_read_b64_tr_b16 v[238:239], v8 offset:19456
v_mfma_f32_16x16x32_bf16 a[12:15], a[148:151], a[124:127], a[12:15]
ds_read_b64_tr_b16 v[240:241], v8 offset:18440
ds_read_b64_tr_b16 v[242:243], v8 offset:19464
v_mfma_f32_16x16x32_bf16 a[32:35], a[148:151], a[132:135], a[32:35]
buffer_load_dwordx4 a[204:207], v4, s[16:19], s41 offen offset:3072
v_mfma_f32_16x16x32_bf16 a[52:55], a[148:151], a[136:139], a[52:55]
v_fma_f32 v186, v174, v184, -v134
v_fma_f32 v187, v174, v185, -v135
v_mfma_f32_16x16x32_bf16 a[16:19], a[152:155], a[124:127], a[16:19]
v_cvt_pk_bf16_f32 v93, v184, v186
v_cvt_pk_bf16_f32 v95, v185, v187
v_mfma_f32_16x16x32_bf16 a[36:39], a[152:155], a[132:135], a[36:39]
v_fma_f32 v180, v175, v138, -v136
v_fma_f32 v181, v175, v139, -v137
v_mfma_f32_16x16x32_bf16 a[56:59], a[152:155], a[136:139], a[56:59]
v_cvt_pk_bf16_f32 v96, v136, v138
v_cvt_pk_bf16_f32 v98, v137, v139
s_waitcnt lgkmcnt(4)
v_mfma_f32_16x16x32_bf16 v[188:191], v[228:231], v[40:43], 0
buffer_load_dwordx4 a[208:211], v5, s[16:19], s41 offen offset:0
v_mfma_f32_16x16x32_bf16 v[192:195], v[232:235], v[40:43], 0
v_fma_f32 v182, v175, v180, -v138
v_fma_f32 v183, v175, v181, -v139
v_mfma_f32_16x16x32_bf16 v[188:191], v[232:235], v[48:51], v[188:191]
v_cvt_pk_bf16_f32 v97, v180, v182
v_cvt_pk_bf16_f32 v99, v181, v183
v_mfma_f32_16x16x32_bf16 v[192:195], v[228:231], v[44:47], v[192:195]
v_fma_f32 v184, v176, v142, -v140
v_fma_f32 v185, v176, v143, -v141
v_mfma_f32_16x16x32_bf16 v[196:199], v[228:231], v[52:55], 0
v_cvt_pk_bf16_f32 v100, v140, v142
v_cvt_pk_bf16_f32 v102, v141, v143
v_mfma_f32_16x16x32_bf16 v[200:203], v[232:235], v[52:55], 0
v_fma_f32 v186, v176, v184, -v142
v_fma_f32 v187, v176, v185, -v143
v_mfma_f32_16x16x32_bf16 v[196:199], v[232:235], v[60:63], v[196:199]
buffer_load_dwordx4 a[212:215], v4, s[16:19], s42 offen offset:3072
v_mfma_f32_16x16x32_bf16 v[200:203], v[228:231], v[56:59], v[200:203]
v_cvt_pk_bf16_f32 v101, v184, v186
v_cvt_pk_bf16_f32 v103, v185, v187
s_waitcnt lgkmcnt(0)
v_mfma_f32_16x16x32_bf16 v[204:207], v[236:239], v[64:67], 0
v_cvt_pk_bf16_f32 v212, v188, v189
v_cvt_pk_bf16_f32 v213, v190, v191
v_mfma_f32_16x16x32_bf16 v[208:211], v[240:243], v[64:67], 0
v_cvt_pk_bf16_f32 v214, v192, v193
v_cvt_pk_bf16_f32 v215, v194, v195
v_mfma_f32_16x16x32_bf16 v[204:207], v[240:243], v[72:75], v[204:207]
v_fma_f32 v180, v177, v146, -v144
v_fma_f32 v181, v177, v147, -v145
v_mfma_f32_16x16x32_bf16 v[208:211], v[236:239], v[68:71], v[208:211]
buffer_load_dwordx4 a[216:219], v5, s[16:19], s42 offen offset:0
v_mfma_f32_16x16x32_bf16 v[188:191], v[236:239], v[76:79], 0
v_cvt_pk_bf16_f32 v216, v196, v197
v_cvt_pk_bf16_f32 v217, v198, v199
v_mfma_f32_16x16x32_bf16 v[192:195], v[240:243], v[76:79], 0
v_cvt_pk_bf16_f32 v218, v200, v201
v_cvt_pk_bf16_f32 v219, v202, v203
v_mfma_f32_16x16x32_bf16 v[188:191], v[240:243], v[84:87], v[188:191]
v_cvt_pk_bf16_f32 v104, v144, v146
v_cvt_pk_bf16_f32 v106, v145, v147
v_mfma_f32_16x16x32_bf16 v[192:195], v[236:239], v[80:83], v[192:195]
v_fma_f32 v182, v177, v180, -v146
v_fma_f32 v183, v177, v181, -v147
v_cvt_pk_bf16_f32 v105, v180, v182
v_cvt_pk_bf16_f32 v107, v181, v183
s_mul_i32 s38, s32, 15360
v_add_u32 v14, s38, v4
s_xor_b32 s38, s35, 0
s_mul_i32 s38, s38, 15360
s_add_u32 s38, s38, 0
v_add_u32 v10, s38, v4
s_xor_b32 s38, s35, 1
s_mul_i32 s38, s38, 15360
s_add_u32 s38, s38, 5120
v_add_u32 v11, s38, v4
s_xor_b32 s38, s35, 2
s_mul_i32 s38, s38, 15360
s_add_u32 s38, s38, 10240
v_add_u32 v12, s38, v4
s_and_b32 s38, s32, 1
s_lshl_b32 s38, s38, 10
s_lshr_b32 s39, s32, 1
s_add_u32 s38, s38, s39
s_lshl_b32 s39, s33, 1
s_add_u32 s38, s38, s39
s_mul_i32 s38, s38, 1280
s_mul_i32 s39, s34, 160
s_add_u32 s63, s38, s39
s_mov_b32 s22, 2621440
s_mov_b32 s23, 0x00020000
v_add_u32 v13, 0, v1
v_mul_u32_u24 v17, 205, v13
v_lshrrev_b32 v17, 11, v17
v_mul_u32_u24 v17, 81760, v17
v_lshl_add_u32 v17, v13, 4, v17
v_add_u32 v13, 64, v1
v_mul_u32_u24 v18, 205, v13
v_lshrrev_b32 v18, 11, v18
v_mul_u32_u24 v18, 81760, v18
v_lshl_add_u32 v18, v13, 4, v18
v_add_u32 v13, 128, v1
v_mul_u32_u24 v19, 205, v13
v_lshrrev_b32 v19, 11, v19
v_mul_u32_u24 v19, 81760, v19
v_lshl_add_u32 v19, v13, 4, v19
v_mul_u32_u24 v15, 160, v3
v_lshl_add_u32 v15, v2, 3, v15
v_add_u32 v15, s66, v15
v_add_u32 v13, s66, v4
v_mfma_f32_16x16x32_bf16 a[0:3], v[88:91], v[212:215], a[0:3]
v_cvt_pk_bf16_f32 v220, v204, v205
v_cvt_pk_bf16_f32 v221, v206, v207
v_mfma_f32_16x16x32_bf16 a[4:7], v[92:95], v[212:215], a[4:7]
v_cvt_pk_bf16_f32 v222, v208, v209
v_cvt_pk_bf16_f32 v223, v210, v211
v_mfma_f32_16x16x32_bf16 a[8:11], v[96:99], v[212:215], a[8:11]
buffer_load_dwordx4 a[220:223], v4, s[16:19], s43 offen offset:0
v_mfma_f32_16x16x32_bf16 a[12:15], v[100:103], v[212:215], a[12:15]
buffer_load_dwordx4 a[224:227], v4, s[16:19], s43 offen offset:1024
v_mfma_f32_16x16x32_bf16 a[16:19], v[104:107], v[212:215], a[16:19]
buffer_load_dwordx4 a[228:231], v4, s[16:19], s43 offen offset:2048
s_waitcnt vmcnt(18)
s_waitcnt vmcnt(13)
v_mfma_f32_16x16x32_bf16 a[0:3], a[156:159], a[176:179], a[0:3]
buffer_load_dwordx4 a[232:235], v4, s[16:19], s43 offen offset:3072
v_mfma_f32_16x16x32_bf16 a[4:7], a[160:163], a[176:179], a[4:7]
v_mfma_f32_16x16x32_bf16 a[8:11], a[164:167], a[176:179], a[8:11]
v_mfma_f32_16x16x32_bf16 a[12:15], a[168:171], a[176:179], a[12:15]
v_mfma_f32_16x16x32_bf16 a[16:19], a[172:175], a[176:179], a[16:19]
s_waitcnt vmcnt(13)
s_waitcnt vmcnt(8)
v_mfma_f32_16x16x32_bf16 a[0:3], a[180:183], a[200:203], a[0:3]
v_mfma_f32_16x16x32_bf16 a[4:7], a[184:187], a[200:203], a[4:7]
buffer_load_dwordx4 a[236:239], v5, s[16:19], s43 offen offset:0
v_mfma_f32_16x16x32_bf16 a[8:11], a[188:191], a[200:203], a[8:11]
v_mfma_f32_16x16x32_bf16 a[12:15], a[192:195], a[200:203], a[12:15]
v_mfma_f32_16x16x32_bf16 a[16:19], a[196:199], a[200:203], a[16:19]
v_mfma_f32_16x16x32_bf16 a[20:23], v[88:91], v[216:219], a[20:23]
v_cvt_pk_bf16_f32 v224, v188, v189
v_cvt_pk_bf16_f32 v225, v190, v191
v_mfma_f32_16x16x32_bf16 a[24:27], v[92:95], v[216:219], a[24:27]
v_cvt_pk_bf16_f32 v226, v192, v193
v_cvt_pk_bf16_f32 v227, v194, v195
v_mfma_f32_16x16x32_bf16 a[28:31], v[96:99], v[216:219], a[28:31]
ds_write_b128 v10, a[0:3] offset:0
v_mfma_f32_16x16x32_bf16 a[32:35], v[100:103], v[216:219], a[32:35]
v_lshlrev_b32 v7, 2, v3
buffer_load_dword v16, v7, s[16:19], s52 offen
v_mfma_f32_16x16x32_bf16 a[36:39], v[104:107], v[216:219], a[36:39]
s_waitcnt vmcnt(9)
v_mfma_f32_16x16x32_bf16 a[20:23], a[156:159], a[204:207], a[20:23]
ds_write_b128 v10, a[4:7] offset:1024
v_mfma_f32_16x16x32_bf16 a[24:27], a[160:163], a[204:207], a[24:27]
v_mfma_f32_16x16x32_bf16 a[28:31], a[164:167], a[204:207], a[28:31]
v_mfma_f32_16x16x32_bf16 a[32:35], a[168:171], a[204:207], a[32:35]
ds_write_b128 v10, a[8:11] offset:2048
v_mfma_f32_16x16x32_bf16 a[36:39], a[172:175], a[204:207], a[36:39]
s_waitcnt vmcnt(8)
v_mfma_f32_16x16x32_bf16 a[20:23], a[180:183], a[208:211], a[20:23]
v_mfma_f32_16x16x32_bf16 a[24:27], a[184:187], a[208:211], a[24:27]
ds_write_b128 v10, a[12:15] offset:3072
v_mfma_f32_16x16x32_bf16 a[28:31], a[188:191], a[208:211], a[28:31]
v_mfma_f32_16x16x32_bf16 a[32:35], a[192:195], a[208:211], a[32:35]
v_mfma_f32_16x16x32_bf16 a[36:39], a[196:199], a[208:211], a[36:39]
ds_write_b128 v10, a[16:19] offset:4096
v_mfma_f32_16x16x32_bf16 a[40:43], v[88:91], v[220:223], a[40:43]
v_mfma_f32_16x16x32_bf16 a[44:47], v[92:95], v[220:223], a[44:47]
v_mfma_f32_16x16x32_bf16 a[48:51], v[96:99], v[220:223], a[48:51]
ds_write_b128 v11, a[20:23] offset:0
v_mfma_f32_16x16x32_bf16 a[52:55], v[100:103], v[220:223], a[52:55]
v_mfma_f32_16x16x32_bf16 a[56:59], v[104:107], v[220:223], a[56:59]
s_waitcnt vmcnt(7)
v_mfma_f32_16x16x32_bf16 a[40:43], a[156:159], a[212:215], a[40:43]
ds_write_b128 v11, a[24:27] offset:1024
v_mfma_f32_16x16x32_bf16 a[44:47], a[160:163], a[212:215], a[44:47]
v_mfma_f32_16x16x32_bf16 a[48:51], a[164:167], a[212:215], a[48:51]
v_mfma_f32_16x16x32_bf16 a[52:55], a[168:171], a[212:215], a[52:55]
ds_write_b128 v11, a[28:31] offset:2048
v_mfma_f32_16x16x32_bf16 a[56:59], a[172:175], a[212:215], a[56:59]
s_waitcnt vmcnt(6)
v_mfma_f32_16x16x32_bf16 a[40:43], a[180:183], a[216:219], a[40:43]
v_mfma_f32_16x16x32_bf16 a[44:47], a[184:187], a[216:219], a[44:47]
ds_write_b128 v11, a[32:35] offset:3072
v_mfma_f32_16x16x32_bf16 a[48:51], a[188:191], a[216:219], a[48:51]
v_mfma_f32_16x16x32_bf16 a[52:55], a[192:195], a[216:219], a[52:55]
v_mfma_f32_16x16x32_bf16 a[56:59], a[196:199], a[216:219], a[56:59]
ds_write_b128 v11, a[36:39] offset:4096
v_mfma_f32_16x16x32_bf16 v[20:23], v[88:91], v[224:227], v[20:23]
v_mfma_f32_16x16x32_bf16 v[24:27], v[92:95], v[224:227], v[24:27]
v_mfma_f32_16x16x32_bf16 v[28:31], v[96:99], v[224:227], v[28:31]
ds_write_b128 v12, a[40:43] offset:0
v_mfma_f32_16x16x32_bf16 v[32:35], v[100:103], v[224:227], v[32:35]
v_mfma_f32_16x16x32_bf16 v[36:39], v[104:107], v[224:227], v[36:39]
s_waitcnt vmcnt(5)
v_mfma_f32_16x16x32_bf16 v[20:23], a[64:67], a[220:223], v[20:23]
ds_write_b128 v12, a[44:47] offset:1024
v_mfma_f32_16x16x32_bf16 v[24:27], a[76:79], a[220:223], v[24:27]
v_mfma_f32_16x16x32_bf16 v[28:31], a[80:83], a[220:223], v[28:31]
v_mfma_f32_16x16x32_bf16 v[32:35], a[84:87], a[220:223], v[32:35]
ds_write_b128 v12, a[48:51] offset:2048
v_mfma_f32_16x16x32_bf16 v[36:39], a[88:91], a[220:223], v[36:39]
s_waitcnt vmcnt(4)
v_mfma_f32_16x16x32_bf16 v[20:23], a[96:99], a[224:227], v[20:23]
v_mfma_f32_16x16x32_bf16 v[24:27], a[108:111], a[224:227], v[24:27]
ds_write_b128 v12, a[52:55] offset:3072
v_mfma_f32_16x16x32_bf16 v[28:31], a[112:115], a[224:227], v[28:31]
v_mfma_f32_16x16x32_bf16 v[32:35], a[116:119], a[224:227], v[32:35]
v_mfma_f32_16x16x32_bf16 v[36:39], a[120:123], a[224:227], v[36:39]
ds_write_b128 v12, a[56:59] offset:4096
s_waitcnt vmcnt(3)
v_mfma_f32_16x16x32_bf16 v[20:23], a[128:131], a[228:231], v[20:23]
s_waitcnt lgkmcnt(0)
s_barrier
v_mfma_f32_16x16x32_bf16 v[24:27], a[140:143], a[228:231], v[24:27]
ds_read_b128 v[40:43], v14 offset:0
ds_read_b128 v[44:47], v14 offset:5120
v_mfma_f32_16x16x32_bf16 v[28:31], a[144:147], a[228:231], v[28:31]
ds_read_b128 v[48:51], v14 offset:10240
ds_read_b128 v[52:55], v14 offset:1024
v_mfma_f32_16x16x32_bf16 v[32:35], a[148:151], a[228:231], v[32:35]
ds_read_b128 v[56:59], v14 offset:6144
ds_read_b128 v[60:63], v14 offset:11264
v_mfma_f32_16x16x32_bf16 v[36:39], a[152:155], a[228:231], v[36:39]
ds_read_b128 v[64:67], v14 offset:2048
ds_read_b128 v[68:71], v14 offset:7168
s_waitcnt vmcnt(2)
v_mfma_f32_16x16x32_bf16 v[20:23], a[156:159], a[232:235], v[20:23]
ds_read_b128 v[72:75], v14 offset:12288
ds_read_b128 v[76:79], v14 offset:3072
v_mfma_f32_16x16x32_bf16 v[24:27], a[160:163], a[232:235], v[24:27]
ds_read_b128 v[80:83], v14 offset:8192
ds_read_b128 v[84:87], v14 offset:13312
v_mfma_f32_16x16x32_bf16 v[28:31], a[164:167], a[232:235], v[28:31]
ds_read_b128 v[88:91], v14 offset:4096
ds_read_b128 v[92:95], v14 offset:9216
v_mfma_f32_16x16x32_bf16 v[32:35], a[168:171], a[232:235], v[32:35]
ds_read_b128 v[96:99], v14 offset:14336
v_mfma_f32_16x16x32_bf16 v[36:39], a[172:175], a[232:235], v[36:39]
s_waitcnt vmcnt(1)
v_mfma_f32_16x16x32_bf16 v[20:23], a[180:183], a[236:239], v[20:23]
v_mfma_f32_16x16x32_bf16 v[24:27], a[184:187], a[236:239], v[24:27]
v_mfma_f32_16x16x32_bf16 v[28:31], a[188:191], a[236:239], v[28:31]
v_mfma_f32_16x16x32_bf16 v[32:35], a[192:195], a[236:239], v[32:35]
v_mfma_f32_16x16x32_bf16 v[36:39], a[196:199], a[236:239], v[36:39]
s_waitcnt vmcnt(0)
s_waitcnt lgkmcnt(12)
v_pk_add_f32 v[40:41], v[40:41], v[44:45]
s_nop 0
v_pk_add_f32 v[20:21], v[20:21], v[48:49]
v_pk_add_f32 v[42:43], v[42:43], v[46:47]
v_pk_add_f32 v[22:23], v[22:23], v[50:51]
v_pk_add_f32 v[40:41], v[40:41], v[20:21]
v_pk_add_f32 v[42:43], v[42:43], v[22:23]
v_pk_mul_f32 v[40:41], v[40:41], v[16:17] op_sel_hi:[1,0]
v_pk_mul_f32 v[42:43], v[42:43], v[16:17] op_sel_hi:[1,0]
v_cvt_pk_bf16_f32 v40, v40, v41
v_cvt_pk_bf16_f32 v41, v42, v43
ds_write_b64 v15, v[40:41] offset:0
s_waitcnt lgkmcnt(10)
v_pk_add_f32 v[52:53], v[52:53], v[56:57]
v_pk_add_f32 v[24:25], v[24:25], v[60:61]
v_pk_add_f32 v[54:55], v[54:55], v[58:59]
v_pk_add_f32 v[26:27], v[26:27], v[62:63]
v_pk_add_f32 v[52:53], v[52:53], v[24:25]
v_pk_add_f32 v[54:55], v[54:55], v[26:27]
v_pk_mul_f32 v[52:53], v[52:53], v[16:17] op_sel_hi:[1,0]
v_pk_mul_f32 v[54:55], v[54:55], v[16:17] op_sel_hi:[1,0]
v_cvt_pk_bf16_f32 v52, v52, v53
v_cvt_pk_bf16_f32 v53, v54, v55
ds_write_b64 v15, v[52:53] offset:32
s_waitcnt lgkmcnt(8)
v_pk_add_f32 v[64:65], v[64:65], v[68:69]
v_pk_add_f32 v[28:29], v[28:29], v[72:73]
v_pk_add_f32 v[66:67], v[66:67], v[70:71]
v_pk_add_f32 v[30:31], v[30:31], v[74:75]
v_pk_add_f32 v[64:65], v[64:65], v[28:29]
v_pk_add_f32 v[66:67], v[66:67], v[30:31]
v_pk_mul_f32 v[64:65], v[64:65], v[16:17] op_sel_hi:[1,0]
v_pk_mul_f32 v[66:67], v[66:67], v[16:17] op_sel_hi:[1,0]
v_cvt_pk_bf16_f32 v64, v64, v65
v_cvt_pk_bf16_f32 v65, v66, v67
ds_write_b64 v15, v[64:65] offset:64
s_waitcnt lgkmcnt(6)
v_pk_add_f32 v[76:77], v[76:77], v[80:81]
v_pk_add_f32 v[32:33], v[32:33], v[84:85]
v_pk_add_f32 v[78:79], v[78:79], v[82:83]
v_pk_add_f32 v[34:35], v[34:35], v[86:87]
v_pk_add_f32 v[76:77], v[76:77], v[32:33]
v_pk_add_f32 v[78:79], v[78:79], v[34:35]
v_pk_mul_f32 v[76:77], v[76:77], v[16:17] op_sel_hi:[1,0]
v_pk_mul_f32 v[78:79], v[78:79], v[16:17] op_sel_hi:[1,0]
v_cvt_pk_bf16_f32 v76, v76, v77
v_cvt_pk_bf16_f32 v77, v78, v79
ds_write_b64 v15, v[76:77] offset:96
s_waitcnt lgkmcnt(4)
v_pk_add_f32 v[88:89], v[88:89], v[92:93]
v_pk_add_f32 v[36:37], v[36:37], v[96:97]
v_pk_add_f32 v[90:91], v[90:91], v[94:95]
v_pk_add_f32 v[38:39], v[38:39], v[98:99]
v_pk_add_f32 v[88:89], v[88:89], v[36:37]
v_pk_add_f32 v[90:91], v[90:91], v[38:39]
v_pk_mul_f32 v[88:89], v[88:89], v[16:17] op_sel_hi:[1,0]
v_pk_mul_f32 v[90:91], v[90:91], v[16:17] op_sel_hi:[1,0]
v_cvt_pk_bf16_f32 v88, v88, v89
v_cvt_pk_bf16_f32 v89, v90, v91
ds_write_b64 v15, v[88:89] offset:128
ds_read_b128 v[188:191], v13 offset:0
ds_read_b128 v[192:195], v13 offset:1024
ds_read_b128 v[196:199], v13 offset:2048
s_waitcnt lgkmcnt(2)
buffer_store_dwordx4 v[188:191], v17, s[20:23], s63 offen sc1
s_waitcnt lgkmcnt(1)
buffer_store_dwordx4 v[192:195], v18, s[20:23], s63 offen sc1
s_waitcnt lgkmcnt(0)
s_mov_b64 exec, 0xffffffff
buffer_store_dwordx4 v[196:199], v19, s[20:23], s63 offen sc1
s_nop 1
k3_end:
s_endpgm
code_end:
.section .rodata,"a"
.p2align 6
.amdhsa_kernel k1_kernel
  .amdhsa_next_free_vgpr 256
  .amdhsa_next_free_sgpr 72
  .amdhsa_accum_offset 256
  .amdhsa_group_segment_fixed_size 0
  .amdhsa_kernarg_size 80
  .amdhsa_user_sgpr_count 2
  .amdhsa_user_sgpr_kernarg_segment_ptr 1
  .amdhsa_system_sgpr_workgroup_id_x 1
.end_amdhsa_kernel
.p2align 6
.amdhsa_kernel k3_kernel
  .amdhsa_next_free_vgpr 512
  .amdhsa_next_free_sgpr 72
  .amdhsa_accum_offset 256
  .amdhsa_group_segment_fixed_size 0
  .amdhsa_kernarg_size 80
  .amdhsa_user_sgpr_count 2
  .amdhsa_user_sgpr_kernarg_segment_ptr 1
  .amdhsa_system_sgpr_workgroup_id_x 1
.end_amdhsa_kernel
```
